```python
import torch

def _softmax(x, axis=-1):
    return torch.softmax(x, dim=axis)
def _gelu(x):
    return torch.nn.functional.gelu(x, approximate="tanh")
def _silu(x):
    return torch.nn.functional.silu(x)
def _sigmoid(x):
    return torch.sigmoid(x)
def _layernorm(x, axis=-1, eps=1e-5):
    m = x.mean(dim=axis, keepdim=True)
    v = x.var(dim=axis, keepdim=True, unbiased=False)
    return (x - m) / torch.sqrt(v + eps)
def _scatter_add(tgt, idx, src, axis=0):
    return tgt.clone().index_add_(axis, idx, src)
def _segment_sum(src, seg, n):
    out = torch.zeros((n,) + src.shape[1:], dtype=src.dtype)
    return out.index_add_(0, seg, src)
def _pad(x, pw):
    flat = tuple(v for pair in reversed(pw) for v in pair)
    return torch.nn.functional.pad(x, flat)

kernel_name = 'interleave_layers__ssm_conv_h3__dense_activation_squared_relu__prompt'

def setup_inputs():

    _w = (lambda a: (lambda t: t.to(torch.bfloat16) if t.is_floating_point() else t)(torch.as_tensor(a)))
    def _A_setup():
        B, S, D = 1, 2048, 1024
        ks = 4
        return {
            "q": _w((lambda *s: torch.randn(*s, dtype=torch.bfloat16) * 0.05)(B, S, D)),
            "k": _w((lambda *s: torch.randn(*s, dtype=torch.bfloat16) * 0.8)(B, S, D)),
            "v": _w((lambda *s: torch.randn(*s, dtype=torch.bfloat16) * 0.8)(B, S, D)),
            "shift_k": _w((lambda *s: torch.randn(*s, dtype=torch.bfloat16) * 0.8)(D, ks) * 0.5),
            "ssm_k": _w((lambda *s: torch.randn(*s, dtype=torch.bfloat16) * 0.8)(D, S) * (1.0 / S ** 0.5)),
            "ssm_D": _w((lambda *s: torch.randn(*s, dtype=torch.bfloat16) * 0.8)(D)),
        }
    _A_in = _A_setup()

    def _B_setup():
        B, S, D, F = 1, 2048, 1024, 3584
        return {
            "x": _w((lambda *s: torch.randn(*s, dtype=torch.bfloat16) * 0.05)(B, S, D)),
            "w1": _w((lambda *s: torch.randn(*s, dtype=torch.bfloat16) * 0.05)(D, F)),
            "b1": _w((lambda *s: torch.randn(*s, dtype=torch.bfloat16) * 0.4)(F)),
            "w2": _w((lambda *s: torch.randn(*s, dtype=torch.bfloat16) * 0.05)(F, D)),
            "b2": _w((lambda *s: torch.randn(*s, dtype=torch.bfloat16) * 3.2)(D)),
        }
    _B_in = _B_setup()

    return {
        "A_q": _A_in["q"],
        "A_k": _A_in["k"],
        "A_v": _A_in["v"],
        "A_shift_k": _A_in["shift_k"],
        "A_ssm_k": _A_in["ssm_k"],
        "A_ssm_D": _A_in["ssm_D"],
        "B_x": _B_in["x"],
        "B_w1": _B_in["w1"],
        "B_b1": _B_in["b1"],
        "B_w2": _B_in["w2"],
        "B_b2": _B_in["b2"],
    }

def reference(A_q, A_k, A_v, A_shift_k, A_ssm_k, A_ssm_D, B_x, B_w1, B_b1, B_w2, B_b2):
    def _A_ref(q, k, v, shift_k, ssm_k, ssm_D):
        B, S, D = q.shape
        ks = shift_k.shape[-1]
        k_pad = _pad(k, ((0, 0), (ks - 1, 0), (0, 0)))
        k_shift = torch.zeros_like(k)
        for t in range(ks):
            k_shift = k_shift + k_pad[:, t:t + S, :] * shift_k[:, ks - 1 - t][None, None, :]
        kv = k_shift * v
        L = 2 * S
        kv_pad = _pad(kv, ((0, 0), (0, S), (0, 0)))
        kf_pad = _pad(ssm_k, ((0, 0), (0, S)))
        kv_f = (lambda x, axes=(-2,-1): torch.fft.rfft2(x.float(), dim=axes))(kv_pad[:, None, :, :], axes=(1, 2))
        kf_f = (lambda x, axes=(-2,-1): torch.fft.rfft2(x.float(), dim=axes))(kf_pad[:, None, :], axes=(1, 2))
        kf_f = (lambda x, *d: x.permute(*d))(kf_f, 1, 2, 0)
        y_f = kv_f * kf_f[None, :, :, :]
        y = (lambda x, s, axes=(-2,-1): torch.fft.irfft2(x, s=s, dim=axes).to(torch.bfloat16))(y_f, (1, L), axes=(1, 2))[:, 0, :S, :]
        y = y + kv * ssm_D[None, None, :]
        return q * y

    def _B_ref(x, w1, b1, w2, b2):
        h = torch.einsum("bsd,df->bsf", x, w1) + b1
        zero = torch.zeros_like(h)
        r = torch.where(h > zero, h, zero)
        h = r * r
        out = torch.einsum("bsf,fd->bsd", h, w2) + b2
        return out

    x = A_q
    x = x + _A_ref(_layernorm(x, axis=-1), A_k, A_v, A_shift_k, A_ssm_k, A_ssm_D)
    x = x + _B_ref(_layernorm(x, axis=-1), B_w1, B_b1, B_w2, B_b2)
    x = x + _A_ref(_layernorm(x, axis=-1), A_k, A_v, A_shift_k, A_ssm_k, A_ssm_D)
    x = x + _B_ref(_layernorm(x, axis=-1), B_w1, B_b1, B_w2, B_b2)
    return x
```

```asm
; @launch kernel=mlp_kernel grid=(256,1,1) block=(512,1,1) lds=152832
.amdgcn_target "amdgcn-amd-amdhsa--gfx950"
.text
.globl mlp_kernel
.p2align 8
.type mlp_kernel,@function
mlp_kernel:
    s_cmp_ge_u32 s2, 256
    s_cbranch_scc1 Lm_end
    v_lshrrev_b32 v1, 6, v0
    s_load_dwordx2 s[6:7], s[0:1], 104
    v_readfirstlane_b32 s3, v1
    v_and_b32 v1, 63, v0
    s_nop 3
    s_cmp_ge_u32 s3, 4
    s_cbranch_scc1 Lf_help
    s_load_dwordx2 s[40:41], s[0:1], 32
    s_setprio 3
    s_load_dwordx4 s[8:11], s[0:1], 8
    s_load_dwordx2 s[12:13], s[0:1], 24
    s_and_b32 s4, s2, 15
    s_lshr_b32 s5, s2, 4
    v_and_b32 v2, 7, v0
    v_lshrrev_b32 v3, 3, v0
    s_lshl_b32 s14, s5, 18
    s_lshl_b32 s15, s4, 7
    s_add_u32 s14, s14, s15
    v_lshlrev_b32 v4, 13, v3
    v_lshl_add_u32 v4, v2, 4, v4
    v_add_u32 v4, s14, v4
    v_subrev_u32 v5, 6144, v4
    v_min_u32 v5, 0x7ffffff0, v5
    s_lshl_b32 s15, s4, 9
    v_lshlrev_b32 v6, 6, v2
    v_add_u32 v6, s15, v6
    s_movk_i32 s50, 0x1000
    s_waitcnt lgkmcnt(0)
    s_mov_b32 s16, s8
    s_and_b32 s17, s9, 0xffff
    s_mov_b32 s18, 4194304
    s_mov_b32 s19, 0x20000
    s_mov_b32 s20, s10
    s_and_b32 s21, s11, 0xffff
    s_mov_b32 s22, 4194304
    s_mov_b32 s23, 0x20000
    s_mov_b32 s24, s12
    s_and_b32 s25, s13, 0xffff
    s_mov_b32 s26, 8192
    s_mov_b32 s27, 0x20000
    buffer_load_dwordx4 v[16:19], v6, s[24:27], 0 offen offset:0
    buffer_load_dwordx4 v[20:23], v6, s[24:27], 0 offen offset:16
    buffer_load_dwordx4 v[24:27], v6, s[24:27], 0 offen offset:32
    buffer_load_dwordx4 v[28:31], v6, s[24:27], 0 offen offset:48
    buffer_load_dwordx4 v[32:35], v5, s[16:19], 0 offen offset:0
    buffer_load_dwordx4 v[36:39], v5, s[16:19], 0 offen offset:2048
    buffer_load_dwordx4 v[40:43], v5, s[16:19], s50 offen offset:0
    buffer_load_dwordx4 v[44:47], v4, s[16:19], 0 offen offset:0
    buffer_load_dwordx4 v[48:51], v4, s[16:19], 0 offen offset:2048
    buffer_load_dwordx4 v[52:55], v4, s[16:19], s50 offen offset:0
    buffer_load_dwordx4 v[56:59], v4, s[16:19], s50 offen offset:2048
    buffer_load_dwordx4 v[60:63], v4, s[20:23], 0 offen offset:0
    buffer_load_dwordx4 v[64:67], v4, s[20:23], 0 offen offset:2048
    buffer_load_dwordx4 v[68:71], v4, s[20:23], s50 offen offset:0
    buffer_load_dwordx4 v[72:75], v4, s[20:23], s50 offen offset:2048
    s_barrier
    s_lshl_b32 s42, s2, 2
    s_add_u32 s42, s42, s3
    s_lshl_b32 s42, s42, 12
    s_add_u32 s36, s40, s42
    s_addc_u32 s37, s41, 0
    s_and_b32 s37, s37, 0xffff
    s_mov_b32 s38, 4096
    s_mov_b32 s39, 0x20000
    s_mul_i32 s43, s3, 25920
    v_lshlrev_b32 v104, 4, v1
    s_add_u32 m0, s43, 0
    s_movk_i32 s42, 4
    buffer_load_dwordx4 v104, s[36:39], s42 offen offset:0 lds
    buffer_load_dwordx4 v104, s[36:39], s42 offen offset:1024 lds
    buffer_load_dwordx4 v104, s[36:39], s42 offen offset:2048 lds
    buffer_load_dwordx4 v104, s[36:39], s42 offen offset:3072 lds
    s_add_u32 m0, s43, 4160
    s_movk_i32 s42, 8
    buffer_load_dwordx4 v104, s[36:39], s42 offen offset:0 lds
    buffer_load_dwordx4 v104, s[36:39], s42 offen offset:1024 lds
    buffer_load_dwordx4 v104, s[36:39], s42 offen offset:2048 lds
    buffer_load_dwordx4 v104, s[36:39], s42 offen offset:3072 lds
    s_add_u32 m0, s43, 8320
    s_movk_i32 s42, 12
    buffer_load_dwordx4 v104, s[36:39], s42 offen offset:0 lds
    buffer_load_dwordx4 v104, s[36:39], s42 offen offset:1024 lds
    buffer_load_dwordx4 v104, s[36:39], s42 offen offset:2048 lds
    buffer_load_dwordx4 v104, s[36:39], s42 offen offset:3072 lds
    s_add_u32 m0, s43, 12480
    s_movk_i32 s42, 16
    buffer_load_dwordx4 v104, s[36:39], s42 offen offset:0 lds
    buffer_load_dwordx4 v104, s[36:39], s42 offen offset:1024 lds
    buffer_load_dwordx4 v104, s[36:39], s42 offen offset:2048 lds
    buffer_load_dwordx4 v104, s[36:39], s42 offen offset:3072 lds
    v_sub_u32 v7, 31, v3
    v_lshlrev_b32 v7, 3, v7
    v_lshlrev_b32 v8, 4, v2
    v_xor_b32 v7, v7, v8
    v_lshl_add_u32 v7, v2, 11, v7
    v_add_u32 v7, 136448, v7
    v_lshrrev_b32 v8, 4, v0
    v_and_b32 v9, 15, v0
    v_lshrrev_b32 v10, 3, v8
    v_xor_b32 v10, v10, v9
    v_lshlrev_b32 v10, 4, v10
    v_lshl_add_u32 v10, v8, 8, v10
    v_add_u32 v10, 136448, v10
    v_lshlrev_b32 v11, 12, v8
    v_lshl_add_u32 v11, v9, 4, v11
    s_lshl_b32 s14, s4, 18
    s_sub_u32 s15, 15, s5
    s_lshl_b32 s15, s15, 8
    s_add_u32 s14, s14, s15
    s_add_u32 s14, s14, 46137344
    s_add_u32 s28, s6, s14
    s_addc_u32 s29, s7, 0
    s_and_b32 s29, s29, 0xffff
    s_mov_b32 s30, 262144
    s_mov_b32 s31, 0x20000
    s_mov_b32 s51, 0x10000
    s_mov_b32 s52, 0x20000
    s_mov_b32 s53, 0x30000
    s_waitcnt vmcnt(20)
    v_lshlrev_b32 v76, 16, v16
    v_and_b32 v77, 0xffff0000, v16
    v_lshlrev_b32 v78, 16, v17
    v_and_b32 v79, 0xffff0000, v17
    v_lshlrev_b32 v80, 16, v32
    v_lshlrev_b32 v81, 16, v36
    v_lshlrev_b32 v82, 16, v40
    v_lshlrev_b32 v83, 16, v44
    v_lshlrev_b32 v84, 16, v48
    v_lshlrev_b32 v85, 16, v52
    v_lshlrev_b32 v86, 16, v56
    v_mul_f32 v88, v79, v80
    v_mul_f32 v89, v79, v81
    v_mul_f32 v90, v79, v82
    v_mul_f32 v91, v79, v83
    v_fmac_f32 v88, v78, v81
    v_fmac_f32 v89, v78, v82
    v_fmac_f32 v90, v78, v83
    v_fmac_f32 v91, v78, v84
    v_fmac_f32 v88, v77, v82
    v_fmac_f32 v89, v77, v83
    v_fmac_f32 v90, v77, v84
    v_fmac_f32 v91, v77, v85
    v_fmac_f32 v88, v76, v83
    v_fmac_f32 v89, v76, v84
    v_fmac_f32 v90, v76, v85
    v_fmac_f32 v91, v76, v86
    s_waitcnt vmcnt(16)
    v_lshlrev_b32 v96, 16, v60
    v_lshlrev_b32 v97, 16, v64
    v_lshlrev_b32 v98, 16, v68
    v_lshlrev_b32 v99, 16, v72
    v_mul_f32 v88, v88, v96
    v_mul_f32 v89, v89, v97
    v_mul_f32 v90, v90, v98
    v_mul_f32 v91, v91, v99
    v_cvt_pk_bf16_f32 v100, v91, v90
    v_cvt_pk_bf16_f32 v101, v89, v88
    ds_write_b64 v7, v[100:101] offset:0
    v_lshlrev_b32 v76, 16, v18
    v_and_b32 v77, 0xffff0000, v18
    v_lshlrev_b32 v78, 16, v19
    v_and_b32 v79, 0xffff0000, v19
    v_and_b32 v80, 0xffff0000, v32
    v_and_b32 v81, 0xffff0000, v36
    v_and_b32 v82, 0xffff0000, v40
    v_and_b32 v83, 0xffff0000, v44
    v_and_b32 v84, 0xffff0000, v48
    v_and_b32 v85, 0xffff0000, v52
    v_and_b32 v86, 0xffff0000, v56
    v_mul_f32 v92, v79, v80
    v_mul_f32 v93, v79, v81
    v_mul_f32 v94, v79, v82
    v_mul_f32 v95, v79, v83
    v_fmac_f32 v92, v78, v81
    v_fmac_f32 v93, v78, v82
    v_fmac_f32 v94, v78, v83
    v_fmac_f32 v95, v78, v84
    v_fmac_f32 v92, v77, v82
    v_fmac_f32 v93, v77, v83
    v_fmac_f32 v94, v77, v84
    v_fmac_f32 v95, v77, v85
    v_fmac_f32 v92, v76, v83
    v_fmac_f32 v93, v76, v84
    v_fmac_f32 v94, v76, v85
    v_fmac_f32 v95, v76, v86
    v_and_b32 v96, 0xffff0000, v60
    v_and_b32 v97, 0xffff0000, v64
    v_and_b32 v98, 0xffff0000, v68
    v_and_b32 v99, 0xffff0000, v72
    v_mul_f32 v92, v92, v96
    v_mul_f32 v93, v93, v97
    v_mul_f32 v94, v94, v98
    v_mul_f32 v95, v95, v99
    v_cvt_pk_bf16_f32 v102, v95, v94
    v_cvt_pk_bf16_f32 v103, v93, v92
    ds_write_b64 v7, v[102:103] offset:256
    v_lshlrev_b32 v76, 16, v20
    v_and_b32 v77, 0xffff0000, v20
    v_lshlrev_b32 v78, 16, v21
    v_and_b32 v79, 0xffff0000, v21
    v_lshlrev_b32 v80, 16, v33
    v_lshlrev_b32 v81, 16, v37
    v_lshlrev_b32 v82, 16, v41
    v_lshlrev_b32 v83, 16, v45
    v_lshlrev_b32 v84, 16, v49
    v_lshlrev_b32 v85, 16, v53
    v_lshlrev_b32 v86, 16, v57
    v_mul_f32 v88, v79, v80
    v_mul_f32 v89, v79, v81
    v_mul_f32 v90, v79, v82
    v_mul_f32 v91, v79, v83
    v_fmac_f32 v88, v78, v81
    v_fmac_f32 v89, v78, v82
    v_fmac_f32 v90, v78, v83
    v_fmac_f32 v91, v78, v84
    v_fmac_f32 v88, v77, v82
    v_fmac_f32 v89, v77, v83
    v_fmac_f32 v90, v77, v84
    v_fmac_f32 v91, v77, v85
    v_fmac_f32 v88, v76, v83
    v_fmac_f32 v89, v76, v84
    v_fmac_f32 v90, v76, v85
    v_fmac_f32 v91, v76, v86
    v_lshlrev_b32 v96, 16, v61
    v_lshlrev_b32 v97, 16, v65
    v_lshlrev_b32 v98, 16, v69
    v_lshlrev_b32 v99, 16, v73
    v_mul_f32 v88, v88, v96
    v_mul_f32 v89, v89, v97
    v_mul_f32 v90, v90, v98
    v_mul_f32 v91, v91, v99
    v_cvt_pk_bf16_f32 v100, v91, v90
    v_cvt_pk_bf16_f32 v101, v89, v88
    ds_write_b64 v7, v[100:101] offset:512
    v_lshlrev_b32 v76, 16, v22
    v_and_b32 v77, 0xffff0000, v22
    v_lshlrev_b32 v78, 16, v23
    v_and_b32 v79, 0xffff0000, v23
    v_and_b32 v80, 0xffff0000, v33
    v_and_b32 v81, 0xffff0000, v37
    v_and_b32 v82, 0xffff0000, v41
    v_and_b32 v83, 0xffff0000, v45
    v_and_b32 v84, 0xffff0000, v49
    v_and_b32 v85, 0xffff0000, v53
    v_and_b32 v86, 0xffff0000, v57
    v_mul_f32 v92, v79, v80
    v_mul_f32 v93, v79, v81
    v_mul_f32 v94, v79, v82
    v_mul_f32 v95, v79, v83
    v_fmac_f32 v92, v78, v81
    v_fmac_f32 v93, v78, v82
    v_fmac_f32 v94, v78, v83
    v_fmac_f32 v95, v78, v84
    v_fmac_f32 v92, v77, v82
    v_fmac_f32 v93, v77, v83
    v_fmac_f32 v94, v77, v84
    v_fmac_f32 v95, v77, v85
    v_fmac_f32 v92, v76, v83
    v_fmac_f32 v93, v76, v84
    v_fmac_f32 v94, v76, v85
    v_fmac_f32 v95, v76, v86
    v_and_b32 v96, 0xffff0000, v61
    v_and_b32 v97, 0xffff0000, v65
    v_and_b32 v98, 0xffff0000, v69
    v_and_b32 v99, 0xffff0000, v73
    v_mul_f32 v92, v92, v96
    v_mul_f32 v93, v93, v97
    v_mul_f32 v94, v94, v98
    v_mul_f32 v95, v95, v99
    v_cvt_pk_bf16_f32 v102, v95, v94
    v_cvt_pk_bf16_f32 v103, v93, v92
    ds_write_b64 v7, v[102:103] offset:768
    v_lshlrev_b32 v76, 16, v24
    v_and_b32 v77, 0xffff0000, v24
    v_lshlrev_b32 v78, 16, v25
    v_and_b32 v79, 0xffff0000, v25
    v_lshlrev_b32 v80, 16, v34
    v_lshlrev_b32 v81, 16, v38
    v_lshlrev_b32 v82, 16, v42
    v_lshlrev_b32 v83, 16, v46
    v_lshlrev_b32 v84, 16, v50
    v_lshlrev_b32 v85, 16, v54
    v_lshlrev_b32 v86, 16, v58
    v_mul_f32 v88, v79, v80
    v_mul_f32 v89, v79, v81
    v_mul_f32 v90, v79, v82
    v_mul_f32 v91, v79, v83
    v_fmac_f32 v88, v78, v81
    v_fmac_f32 v89, v78, v82
    v_fmac_f32 v90, v78, v83
    v_fmac_f32 v91, v78, v84
    v_fmac_f32 v88, v77, v82
    v_fmac_f32 v89, v77, v83
    v_fmac_f32 v90, v77, v84
    v_fmac_f32 v91, v77, v85
    v_fmac_f32 v88, v76, v83
    v_fmac_f32 v89, v76, v84
    v_fmac_f32 v90, v76, v85
    v_fmac_f32 v91, v76, v86
    v_lshlrev_b32 v96, 16, v62
    v_lshlrev_b32 v97, 16, v66
    v_lshlrev_b32 v98, 16, v70
    v_lshlrev_b32 v99, 16, v74
    v_mul_f32 v88, v88, v96
    v_mul_f32 v89, v89, v97
    v_mul_f32 v90, v90, v98
    v_mul_f32 v91, v91, v99
    v_cvt_pk_bf16_f32 v100, v91, v90
    v_cvt_pk_bf16_f32 v101, v89, v88
    ds_write_b64 v7, v[100:101] offset:1024
    v_lshlrev_b32 v76, 16, v26
    v_and_b32 v77, 0xffff0000, v26
    v_lshlrev_b32 v78, 16, v27
    v_and_b32 v79, 0xffff0000, v27
    v_and_b32 v80, 0xffff0000, v34
    v_and_b32 v81, 0xffff0000, v38
    v_and_b32 v82, 0xffff0000, v42
    v_and_b32 v83, 0xffff0000, v46
    v_and_b32 v84, 0xffff0000, v50
    v_and_b32 v85, 0xffff0000, v54
    v_and_b32 v86, 0xffff0000, v58
    v_mul_f32 v92, v79, v80
    v_mul_f32 v93, v79, v81
    v_mul_f32 v94, v79, v82
    v_mul_f32 v95, v79, v83
    v_fmac_f32 v92, v78, v81
    v_fmac_f32 v93, v78, v82
    v_fmac_f32 v94, v78, v83
    v_fmac_f32 v95, v78, v84
    v_fmac_f32 v92, v77, v82
    v_fmac_f32 v93, v77, v83
    v_fmac_f32 v94, v77, v84
    v_fmac_f32 v95, v77, v85
    v_fmac_f32 v92, v76, v83
    v_fmac_f32 v93, v76, v84
    v_fmac_f32 v94, v76, v85
    v_fmac_f32 v95, v76, v86
    v_and_b32 v96, 0xffff0000, v62
    v_and_b32 v97, 0xffff0000, v66
    v_and_b32 v98, 0xffff0000, v70
    v_and_b32 v99, 0xffff0000, v74
    v_mul_f32 v92, v92, v96
    v_mul_f32 v93, v93, v97
    v_mul_f32 v94, v94, v98
    v_mul_f32 v95, v95, v99
    v_cvt_pk_bf16_f32 v102, v95, v94
    v_cvt_pk_bf16_f32 v103, v93, v92
    ds_write_b64 v7, v[102:103] offset:1280
    v_lshlrev_b32 v76, 16, v28
    v_and_b32 v77, 0xffff0000, v28
    v_lshlrev_b32 v78, 16, v29
    v_and_b32 v79, 0xffff0000, v29
    v_lshlrev_b32 v80, 16, v35
    v_lshlrev_b32 v81, 16, v39
    v_lshlrev_b32 v82, 16, v43
    v_lshlrev_b32 v83, 16, v47
    v_lshlrev_b32 v84, 16, v51
    v_lshlrev_b32 v85, 16, v55
    v_lshlrev_b32 v86, 16, v59
    v_mul_f32 v88, v79, v80
    v_mul_f32 v89, v79, v81
    v_mul_f32 v90, v79, v82
    v_mul_f32 v91, v79, v83
    v_fmac_f32 v88, v78, v81
    v_fmac_f32 v89, v78, v82
    v_fmac_f32 v90, v78, v83
    v_fmac_f32 v91, v78, v84
    v_fmac_f32 v88, v77, v82
    v_fmac_f32 v89, v77, v83
    v_fmac_f32 v90, v77, v84
    v_fmac_f32 v91, v77, v85
    v_fmac_f32 v88, v76, v83
    v_fmac_f32 v89, v76, v84
    v_fmac_f32 v90, v76, v85
    v_fmac_f32 v91, v76, v86
    v_lshlrev_b32 v96, 16, v63
    v_lshlrev_b32 v97, 16, v67
    v_lshlrev_b32 v98, 16, v71
    v_lshlrev_b32 v99, 16, v75
    v_mul_f32 v88, v88, v96
    v_mul_f32 v89, v89, v97
    v_mul_f32 v90, v90, v98
    v_mul_f32 v91, v91, v99
    v_cvt_pk_bf16_f32 v100, v91, v90
    v_cvt_pk_bf16_f32 v101, v89, v88
    ds_write_b64 v7, v[100:101] offset:1536
    v_lshlrev_b32 v76, 16, v30
    v_and_b32 v77, 0xffff0000, v30
    v_lshlrev_b32 v78, 16, v31
    v_and_b32 v79, 0xffff0000, v31
    v_and_b32 v80, 0xffff0000, v35
    v_and_b32 v81, 0xffff0000, v39
    v_and_b32 v82, 0xffff0000, v43
    v_and_b32 v83, 0xffff0000, v47
    v_and_b32 v84, 0xffff0000, v51
    v_and_b32 v85, 0xffff0000, v55
    v_and_b32 v86, 0xffff0000, v59
    v_mul_f32 v92, v79, v80
    v_mul_f32 v93, v79, v81
    v_mul_f32 v94, v79, v82
    v_mul_f32 v95, v79, v83
    v_fmac_f32 v92, v78, v81
    v_fmac_f32 v93, v78, v82
    v_fmac_f32 v94, v78, v83
    v_fmac_f32 v95, v78, v84
    v_fmac_f32 v92, v77, v82
    v_fmac_f32 v93, v77, v83
    v_fmac_f32 v94, v77, v84
    v_fmac_f32 v95, v77, v85
    v_fmac_f32 v92, v76, v83
    v_fmac_f32 v93, v76, v84
    v_fmac_f32 v94, v76, v85
    v_fmac_f32 v95, v76, v86
    v_and_b32 v96, 0xffff0000, v63
    v_and_b32 v97, 0xffff0000, v67
    v_and_b32 v98, 0xffff0000, v71
    v_and_b32 v99, 0xffff0000, v75
    v_mul_f32 v92, v92, v96
    v_mul_f32 v93, v93, v97
    v_mul_f32 v94, v94, v98
    v_mul_f32 v95, v95, v99
    v_cvt_pk_bf16_f32 v102, v95, v94
    v_cvt_pk_bf16_f32 v103, v93, v92
    ds_write_b64 v7, v[102:103] offset:1792
    s_waitcnt lgkmcnt(0)
    s_barrier
    s_load_dwordx2 s[64:65], s[0:1], 96
    v_mov_b32 v82, 0
    s_waitcnt lgkmcnt(0)
    s_and_b32 s65, s65, 0xffff
    s_mov_b32 s66, 8
    s_mov_b32 s67, 0x20000
    s_mov_b32 s58, 0x40000
    s_cmp_lg_u32 s3, 0
    s_cbranch_scc1 Lp_n
    buffer_load_dwordx2 v[86:87], v82, s[64:67], 0 offen sc1
Lp_n:
    ds_read_b128 v[16:19], v10 offset:0
    v_xor_b32 v12, 32, v10
    ds_read_b128 v[20:23], v12 offset:4096
    v_xor_b32 v13, 64, v10
    ds_read_b128 v[24:27], v13 offset:8192
    v_xor_b32 v14, 96, v10
    ds_read_b128 v[28:31], v14 offset:12288
    s_waitcnt lgkmcnt(3)
    buffer_store_dwordx4 v[16:19], v11, s[28:31], 0 offen sc1
    s_waitcnt lgkmcnt(2)
    buffer_store_dwordx4 v[20:23], v11, s[28:31], s51 offen sc1
    s_waitcnt lgkmcnt(1)
    buffer_store_dwordx4 v[24:27], v11, s[28:31], s52 offen sc1
    s_waitcnt lgkmcnt(0)
    buffer_store_dwordx4 v[28:31], v11, s[28:31], s53 offen sc1
    s_lshl_b32 s28, s2, 10
    s_add_u32 s28, s28, 58720256
    s_add_u32 s32, s6, s28
    s_addc_u32 s33, s7, 0
    s_and_b32 s33, s33, 0xffff
    s_mov_b32 s34, 640
    s_mov_b32 s35, 0x20000
    v_lshlrev_b32 v14, 7, v0
    v_mov_b32 v15, 0
    buffer_store_dword v15, v14, s[32:35], 0 offen sc1
    s_waitcnt vmcnt(0)
    s_barrier
    s_cmp_lg_u32 s3, 0
    s_cbranch_scc1 Lc_nh
Lp_np:
    s_waitcnt vmcnt(0)
    v_readfirstlane_b32 s72, v86
    v_readfirstlane_b32 s73, v87
    s_nop 3
    s_cmp_lg_u64 s[72:73], 0
    s_cbranch_scc1 Lp_ng
    s_sub_u32 s58, s58, 1
    s_cbranch_scc1 Lp_ng
    buffer_load_dwordx2 v[86:87], v82, s[64:67], 0 offen sc1
    s_branch Lp_np
Lp_ng:
    s_add_u32 s64, s6, 58720256
    s_addc_u32 s65, s7, 0
    s_and_b32 s65, s65, 0xffff
    s_mov_b32 s66, 262144
    s_mov_b32 s67, 0x20000
    v_and_b32 v80, 63, v0
    v_mov_b32 v86, s72
    v_mov_b32 v87, s73
    v_mov_b32 v82, 0
    s_lshl_b32 s68, s2, 10
    s_mov_b64 exec, 1
    buffer_store_dwordx2 v[86:87], v82, s[64:67], s68 offen offset:640 sc1
    s_mov_b64 exec, -1
    s_lshr_b32 s69, s2, 4
    s_lshl_b32 s69, s69, 10
    v_lshlrev_b32 v80, 14, v80
    s_mov_b64 exec, 0xffff
    s_mov_b32 s58, 0x40000
Lc1_hp:
    buffer_load_dwordx2 v[84:85], v80, s[64:67], s69 offen offset:640 sc1
    s_sub_u32 s58, s58, 1
    s_cbranch_scc1 Lc1_hg
    s_waitcnt vmcnt(0)
    v_cmp_ne_u64 vcc, s[72:73], v[84:85]
    s_cbranch_vccnz Lc1_hp
Lc1_hg:
    s_waitcnt vmcnt(0)
    s_mov_b64 exec, -1
Lc_nh:
    s_load_dwordx4 s[8:11], s[0:1], 32
    s_lshl_b32 s4, s2, 2
    s_add_u32 s4, s4, s3
    s_lshl_b32 s5, s4, 12
    s_mul_i32 s53, s3, 25920
    v_lshlrev_b32 v2, 4, v1
    v_and_b32 v3, 15, v1
    v_lshrrev_b32 v4, 4, v1
    v_lshlrev_b32 v5, 2, v3
    v_lshl_add_u32 v5, v4, 4, v5
    v_subrev_u32 v5, 60, v5
    v_add_u32 v6, 4, v5
    v_add_u32 v7, 8, v5
    v_add_u32 v8, 12, v5
    v_min_u32 v5, 0x7ffffff0, v5
    v_min_u32 v6, 0x7ffffff0, v6
    v_min_u32 v7, 0x7ffffff0, v7
    v_min_u32 v8, 0x7ffffff0, v8
    s_add_u32 s12, s5, 46137344
    s_lshl_b32 s13, s4, 1
    s_and_b32 s13, s13, -4
    s_waitcnt lgkmcnt(0)
    s_add_u32 s16, s6, s12
    s_addc_u32 s17, s7, 0
    s_and_b32 s17, s17, 0xffff
    s_mov_b32 s18, 4096
    s_mov_b32 s19, 0x20000
    s_add_u32 s20, s8, s5
    s_addc_u32 s21, s9, 0
    s_and_b32 s21, s21, 0xffff
    s_mov_b32 s22, 4096
    s_mov_b32 s23, 0x20000
    s_load_dword s14, s[10:11], s13
    s_barrier
    buffer_load_dwordx4 v[48:51], v2, s[16:19], 0 offen offset:0
    buffer_load_dword v52, v2, s[16:19], 0 offen offset:16
    buffer_load_dwordx4 v[54:57], v2, s[16:19], 0 offen offset:1024
    buffer_load_dword v58, v2, s[16:19], 0 offen offset:1040
    buffer_load_dwordx4 v[60:63], v2, s[16:19], 0 offen offset:2048
    buffer_load_dword v64, v2, s[16:19], 0 offen offset:2064
    buffer_load_dwordx4 v[66:69], v2, s[16:19], 0 offen offset:3072
    buffer_load_dword v70, v2, s[16:19], 0 offen offset:3088
    buffer_load_dword v16, v5, s[20:23], 0 offen
    buffer_load_dword v17, v6, s[20:23], 0 offen
    buffer_load_dword v18, v7, s[20:23], 0 offen
    buffer_load_dword v19, v8, s[20:23], 0 offen
    s_lshl_b32 s12, s2, 7
    s_add_u32 s12, s12, 14680064
    s_add_u32 s24, s6, s12
    s_addc_u32 s25, s7, 0
    s_and_b32 s25, s25, 0xffff
    s_mov_b32 s26, 4161664
    s_mov_b32 s27, 0x20000
    v_mov_b32 v12, 0
    v_mov_b32 v13, 0
    v_mov_b32 v14, 0
    v_mov_b32 v15, 0
    s_add_u32 s54, s53, 16640
    v_add_u32 v9, s54, v2
    s_mov_b64 exec, 0xfffffff
    ds_write_b128 v9, v[12:15] offset:4096
    ds_write_b128 v9, v[12:15] offset:8736
    s_mov_b64 exec, -1
    s_waitcnt lgkmcnt(0)
    s_bitcmp1_b32 s4, 0
    s_cselect_b32 s15, 16, 0
    s_lshr_b32 s14, s14, s15
    s_and_b32 s14, s14, 0xffff
    v_mov_b32 v10, s14
    v_cmp_eq_u32 vcc, 0, v5
    s_nop 1
    v_cndmask_b32 v12, 0, v10, vcc
    v_cmp_eq_u32 vcc, 0, v6
    s_nop 1
    v_cndmask_b32 v13, 0, v10, vcc
    v_cmp_eq_u32 vcc, 0, v7
    s_nop 1
    v_cndmask_b32 v14, 0, v10, vcc
    v_cmp_eq_u32 vcc, 0, v8
    s_nop 1
    v_cndmask_b32 v15, 0, v10, vcc
    s_waitcnt vmcnt(10)
    v_alignbyte_b32 v80, v49, v48, 2
    v_alignbyte_b32 v81, v50, v49, 2
    v_alignbyte_b32 v82, v51, v50, 2
    v_alignbyte_b32 v83, v52, v51, 2
    ds_write_b128 v9, v[80:83] offset:0
    ds_write_b128 v9, v[48:51] offset:4640
    s_waitcnt vmcnt(8)
    v_alignbyte_b32 v84, v55, v54, 2
    v_alignbyte_b32 v85, v56, v55, 2
    v_alignbyte_b32 v86, v57, v56, 2
    v_alignbyte_b32 v87, v58, v57, 2
    ds_write_b128 v9, v[84:87] offset:1024
    ds_write_b128 v9, v[54:57] offset:5664
    s_waitcnt vmcnt(6)
    v_alignbyte_b32 v88, v61, v60, 2
    v_alignbyte_b32 v89, v62, v61, 2
    v_alignbyte_b32 v90, v63, v62, 2
    v_alignbyte_b32 v91, v64, v63, 2
    ds_write_b128 v9, v[88:91] offset:2048
    ds_write_b128 v9, v[60:63] offset:6688
    s_waitcnt vmcnt(4)
    v_alignbyte_b32 v92, v67, v66, 2
    v_alignbyte_b32 v93, v68, v67, 2
    v_alignbyte_b32 v94, v69, v68, 2
    v_alignbyte_b32 v95, v70, v69, 2
    ds_write_b128 v9, v[92:95] offset:3072
    ds_write_b128 v9, v[66:69] offset:7712
    v_and_b32 v5, 3, v3
    v_mul_u32_u24 v5, 4160, v5
    v_lshrrev_b32 v6, 2, v3
    v_add_u32 v6, v6, v4
    v_lshl_add_u32 v5, v6, 4, v5
    v_add_u32 v5, s53, v5
    v_and_b32 v8, 1, v3
    v_mul_u32_u24 v6, 4640, v8
    v_lshrrev_b32 v7, 1, v3
    v_lshlrev_b32 v10, 2, v7
    v_sub_u32 v10, v4, v10
    v_add_u32 v10, 28, v10
    v_lshl_add_u32 v6, v10, 4, v6
    v_add_u32 v6, s54, v6
    v_lshlrev_b32 v7, 6, v7
    v_lshl_add_u32 v7, v4, 4, v7
    v_lshl_add_u32 v7, v8, 3, v7
    v_add_u32 v7, s53, v7
    s_waitcnt vmcnt(0) lgkmcnt(0)
    s_load_dwordx2 s[92:93], s[0:1], 0
    s_lshl_b32 s91, s2, 14
    v_lshrrev_b32 v208, 6, v0
    v_lshlrev_b32 v208, 11, v208
    v_lshl_add_u32 v208, v1, 4, v208
    s_waitcnt lgkmcnt(0)
    s_and_b32 s93, s93, 0xffff
    s_mov_b32 s94, 4194304
    s_mov_b32 s95, 0x20000
    buffer_load_dwordx4 v[200:203], v208, s[92:95], s91 offen
    buffer_load_dwordx4 v[204:207], v208, s[92:95], s91 offen offset:1024
.p2align 3
    ds_read_b128 v[48:51], v6 offset:3584
    ds_read_b128 v[44:47], v5 offset:3520
    ds_read_b128 v[52:55], v6 offset:3072
    ds_read_b128 v[40:43], v5 offset:3008
    ds_read_b128 v[56:59], v6 offset:2560
    ds_read_b128 v[36:39], v5 offset:2496
    ds_read_b128 v[60:63], v6 offset:2048
    ds_read_b128 v[32:35], v5 offset:1984
    ds_read_b128 v[64:67], v6 offset:1536
    ds_read_b128 v[28:31], v5 offset:1472
    ds_read_b128 v[68:71], v6 offset:1024
    ds_read_b128 v[24:27], v5 offset:960
    ds_read_b128 v[72:75], v6 offset:512
    ds_read_b128 v[20:23], v5 offset:448
    ds_read_b128 v[76:79], v6 offset:0
    s_waitcnt lgkmcnt(14)
    s_nop 0
    v_mfma_f32_16x16x32_bf16 v[112:115], v[12:15], v[48:51], 0
    s_waitcnt lgkmcnt(12)
    s_nop 0
    v_mfma_f32_16x16x32_bf16 v[116:119], v[12:15], v[52:55], 0
    s_waitcnt lgkmcnt(10)
    s_nop 0
    v_mfma_f32_16x16x32_bf16 v[120:123], v[12:15], v[56:59], 0
    s_waitcnt lgkmcnt(8)
    s_nop 0
    v_mfma_f32_16x16x32_bf16 v[124:127], v[12:15], v[60:63], 0
    s_waitcnt lgkmcnt(6)
    s_nop 0
    v_mfma_f32_16x16x32_bf16 v[128:131], v[12:15], v[64:67], 0
    s_waitcnt lgkmcnt(4)
    s_nop 0
    v_mfma_f32_16x16x32_bf16 v[132:135], v[12:15], v[68:71], 0
    s_waitcnt lgkmcnt(2)
    s_nop 0
    v_mfma_f32_16x16x32_bf16 v[136:139], v[12:15], v[72:75], 0
    s_waitcnt lgkmcnt(0)
    s_nop 0
    v_mfma_f32_16x16x32_bf16 v[140:143], v[12:15], v[76:79], 0
    v_mfma_f32_16x16x32_bf16 v[140:143], v[44:47], v[48:51], v[140:143]
    ds_read_b128 v[44:47], v5 offset:3584
    v_mfma_f32_16x16x32_bf16 v[136:139], v[40:43], v[48:51], v[136:139]
    v_mfma_f32_16x16x32_bf16 v[140:143], v[40:43], v[52:55], v[140:143]
    ds_read_b128 v[40:43], v5 offset:3072
    v_mfma_f32_16x16x32_bf16 v[132:135], v[36:39], v[48:51], v[132:135]
    ds_read_b128 v[80:83], v6 offset:3648
    v_mfma_f32_16x16x32_bf16 v[136:139], v[36:39], v[52:55], v[136:139]
    v_mfma_f32_16x16x32_bf16 v[140:143], v[36:39], v[56:59], v[140:143]
    ds_read_b128 v[84:87], v6 offset:3136
    ds_read_b128 v[36:39], v5 offset:2560
    v_mfma_f32_16x16x32_bf16 v[128:131], v[32:35], v[48:51], v[128:131]
    ds_read_b128 v[88:91], v6 offset:2624
    v_mfma_f32_16x16x32_bf16 v[132:135], v[32:35], v[52:55], v[132:135]
    v_mfma_f32_16x16x32_bf16 v[136:139], v[32:35], v[56:59], v[136:139]
    ds_read_b128 v[92:95], v6 offset:2112
    v_mfma_f32_16x16x32_bf16 v[140:143], v[32:35], v[60:63], v[140:143]
    ds_read_b128 v[32:35], v5 offset:2048
    v_mfma_f32_16x16x32_bf16 v[124:127], v[28:31], v[48:51], v[124:127]
    ds_read_b128 v[96:99], v6 offset:1600
    v_mfma_f32_16x16x32_bf16 v[128:131], v[28:31], v[52:55], v[128:131]
    v_mfma_f32_16x16x32_bf16 v[132:135], v[28:31], v[56:59], v[132:135]
    ds_read_b128 v[100:103], v6 offset:1088
    v_mfma_f32_16x16x32_bf16 v[136:139], v[28:31], v[60:63], v[136:139]
    v_mfma_f32_16x16x32_bf16 v[140:143], v[28:31], v[64:67], v[140:143]
    ds_read_b128 v[28:31], v5 offset:1536
    v_mfma_f32_16x16x32_bf16 v[120:123], v[24:27], v[48:51], v[120:123]
    ds_read_b128 v[104:107], v6 offset:576
    v_mfma_f32_16x16x32_bf16 v[124:127], v[24:27], v[52:55], v[124:127]
    v_mfma_f32_16x16x32_bf16 v[128:131], v[24:27], v[56:59], v[128:131]
    ds_read_b128 v[108:111], v6 offset:64
    v_mfma_f32_16x16x32_bf16 v[132:135], v[24:27], v[60:63], v[132:135]
    v_mfma_f32_16x16x32_bf16 v[136:139], v[24:27], v[64:67], v[136:139]
    v_mfma_f32_16x16x32_bf16 v[140:143], v[24:27], v[68:71], v[140:143]
    ds_read_b128 v[24:27], v5 offset:1024
    v_mfma_f32_16x16x32_bf16 v[116:119], v[20:23], v[48:51], v[116:119]
    v_mfma_f32_16x16x32_bf16 v[120:123], v[20:23], v[52:55], v[120:123]
    v_mfma_f32_16x16x32_bf16 v[124:127], v[20:23], v[56:59], v[124:127]
    v_mfma_f32_16x16x32_bf16 v[128:131], v[20:23], v[60:63], v[128:131]
    v_mfma_f32_16x16x32_bf16 v[132:135], v[20:23], v[64:67], v[132:135]
    v_mfma_f32_16x16x32_bf16 v[136:139], v[20:23], v[68:71], v[136:139]
    v_mfma_f32_16x16x32_bf16 v[140:143], v[20:23], v[72:75], v[140:143]
    ds_read_b128 v[20:23], v5 offset:512
    v_mfma_f32_16x16x32_bf16 v[112:115], v[16:19], v[48:51], v[112:115]
    v_mfma_f32_16x16x32_bf16 v[116:119], v[16:19], v[52:55], v[116:119]
    v_mfma_f32_16x16x32_bf16 v[120:123], v[16:19], v[56:59], v[120:123]
    v_mfma_f32_16x16x32_bf16 v[124:127], v[16:19], v[60:63], v[124:127]
    v_mfma_f32_16x16x32_bf16 v[128:131], v[16:19], v[64:67], v[128:131]
    v_mfma_f32_16x16x32_bf16 v[132:135], v[16:19], v[68:71], v[132:135]
    v_mfma_f32_16x16x32_bf16 v[136:139], v[16:19], v[72:75], v[136:139]
    v_mfma_f32_16x16x32_bf16 v[140:143], v[16:19], v[76:79], v[140:143]
    ds_read_b128 v[16:19], v5 offset:0
    s_waitcnt lgkmcnt(13)
    s_nop 0
    v_mfma_f32_16x16x32_bf16 v[140:143], v[44:47], v[80:83], v[140:143]
    ds_read_b128 v[44:47], v5 offset:3648
    v_mfma_f32_16x16x32_bf16 v[136:139], v[40:43], v[80:83], v[136:139]
    s_waitcnt lgkmcnt(13)
    s_nop 0
    v_mfma_f32_16x16x32_bf16 v[140:143], v[40:43], v[84:87], v[140:143]
    ds_read_b128 v[40:43], v5 offset:3136
    s_waitcnt lgkmcnt(13)
    s_nop 0
    v_mfma_f32_16x16x32_bf16 v[132:135], v[36:39], v[80:83], v[132:135]
    ds_read_b128 v[48:51], v6 offset:3712
    v_mfma_f32_16x16x32_bf16 v[136:139], v[36:39], v[84:87], v[136:139]
    s_waitcnt lgkmcnt(13)
    s_nop 0
    v_mfma_f32_16x16x32_bf16 v[140:143], v[36:39], v[88:91], v[140:143]
    ds_read_b128 v[52:55], v6 offset:3200
    ds_read_b128 v[36:39], v5 offset:2624
    s_waitcnt lgkmcnt(13)
    s_nop 0
    v_mfma_f32_16x16x32_bf16 v[128:131], v[32:35], v[80:83], v[128:131]
    ds_read_b128 v[56:59], v6 offset:2688
    v_mfma_f32_16x16x32_bf16 v[132:135], v[32:35], v[84:87], v[132:135]
    v_mfma_f32_16x16x32_bf16 v[136:139], v[32:35], v[88:91], v[136:139]
    ds_read_b128 v[60:63], v6 offset:2176
    v_mfma_f32_16x16x32_bf16 v[140:143], v[32:35], v[92:95], v[140:143]
    ds_read_b128 v[32:35], v5 offset:2112
    s_waitcnt lgkmcnt(13)
    s_nop 0
    v_mfma_f32_16x16x32_bf16 v[124:127], v[28:31], v[80:83], v[124:127]
    ds_read_b128 v[64:67], v6 offset:1664
    v_mfma_f32_16x16x32_bf16 v[128:131], v[28:31], v[84:87], v[128:131]
    v_mfma_f32_16x16x32_bf16 v[132:135], v[28:31], v[88:91], v[132:135]
    ds_read_b128 v[68:71], v6 offset:1152
    v_mfma_f32_16x16x32_bf16 v[136:139], v[28:31], v[92:95], v[136:139]
    v_mfma_f32_16x16x32_bf16 v[140:143], v[28:31], v[96:99], v[140:143]
    ds_read_b128 v[28:31], v5 offset:1600
    s_waitcnt lgkmcnt(13)
    s_nop 0
    v_mfma_f32_16x16x32_bf16 v[120:123], v[24:27], v[80:83], v[120:123]
    ds_read_b128 v[72:75], v6 offset:640
    v_mfma_f32_16x16x32_bf16 v[124:127], v[24:27], v[84:87], v[124:127]
    v_mfma_f32_16x16x32_bf16 v[128:131], v[24:27], v[88:91], v[128:131]
    ds_read_b128 v[76:79], v6 offset:128
    v_mfma_f32_16x16x32_bf16 v[132:135], v[24:27], v[92:95], v[132:135]
    v_mfma_f32_16x16x32_bf16 v[136:139], v[24:27], v[96:99], v[136:139]
    v_mfma_f32_16x16x32_bf16 v[140:143], v[24:27], v[100:103], v[140:143]
    ds_read_b128 v[24:27], v5 offset:1088
    s_waitcnt lgkmcnt(15)
    s_nop 0
    v_mfma_f32_16x16x32_bf16 v[116:119], v[20:23], v[80:83], v[116:119]
    v_mfma_f32_16x16x32_bf16 v[120:123], v[20:23], v[84:87], v[120:123]
    v_mfma_f32_16x16x32_bf16 v[124:127], v[20:23], v[88:91], v[124:127]
    v_mfma_f32_16x16x32_bf16 v[128:131], v[20:23], v[92:95], v[128:131]
    v_mfma_f32_16x16x32_bf16 v[132:135], v[20:23], v[96:99], v[132:135]
    v_mfma_f32_16x16x32_bf16 v[136:139], v[20:23], v[100:103], v[136:139]
    v_mfma_f32_16x16x32_bf16 v[140:143], v[20:23], v[104:107], v[140:143]
    ds_read_b128 v[20:23], v5 offset:576
    s_waitcnt lgkmcnt(15)
    s_nop 0
    v_mfma_f32_16x16x32_bf16 v[112:115], v[16:19], v[80:83], v[112:115]
    v_mfma_f32_16x16x32_bf16 v[116:119], v[16:19], v[84:87], v[116:119]
    v_mfma_f32_16x16x32_bf16 v[120:123], v[16:19], v[88:91], v[120:123]
    v_mfma_f32_16x16x32_bf16 v[124:127], v[16:19], v[92:95], v[124:127]
    v_mfma_f32_16x16x32_bf16 v[128:131], v[16:19], v[96:99], v[128:131]
    v_mfma_f32_16x16x32_bf16 v[132:135], v[16:19], v[100:103], v[132:135]
    v_mfma_f32_16x16x32_bf16 v[136:139], v[16:19], v[104:107], v[136:139]
    v_mfma_f32_16x16x32_bf16 v[140:143], v[16:19], v[108:111], v[140:143]
    ds_read_b128 v[16:19], v5 offset:64
    s_waitcnt lgkmcnt(13)
    s_nop 0
    v_mfma_f32_16x16x32_bf16 v[140:143], v[44:47], v[48:51], v[140:143]
    ds_read_b128 v[44:47], v5 offset:3712
    v_mfma_f32_16x16x32_bf16 v[136:139], v[40:43], v[48:51], v[136:139]
    s_waitcnt lgkmcnt(13)
    s_nop 0
    v_mfma_f32_16x16x32_bf16 v[140:143], v[40:43], v[52:55], v[140:143]
    ds_read_b128 v[40:43], v5 offset:3200
    s_waitcnt lgkmcnt(13)
    s_nop 0
    v_mfma_f32_16x16x32_bf16 v[132:135], v[36:39], v[48:51], v[132:135]
    ds_read_b128 v[80:83], v6 offset:3776
    v_mfma_f32_16x16x32_bf16 v[136:139], v[36:39], v[52:55], v[136:139]
    s_waitcnt lgkmcnt(13)
    s_nop 0
    v_mfma_f32_16x16x32_bf16 v[140:143], v[36:39], v[56:59], v[140:143]
    ds_read_b128 v[84:87], v6 offset:3264
    ds_read_b128 v[36:39], v5 offset:2688
    s_waitcnt lgkmcnt(13)
    s_nop 0
    v_mfma_f32_16x16x32_bf16 v[128:131], v[32:35], v[48:51], v[128:131]
    ds_read_b128 v[88:91], v6 offset:2752
    v_mfma_f32_16x16x32_bf16 v[132:135], v[32:35], v[52:55], v[132:135]
    v_mfma_f32_16x16x32_bf16 v[136:139], v[32:35], v[56:59], v[136:139]
    ds_read_b128 v[92:95], v6 offset:2240
    v_mfma_f32_16x16x32_bf16 v[140:143], v[32:35], v[60:63], v[140:143]
    ds_read_b128 v[32:35], v5 offset:2176
    s_waitcnt lgkmcnt(13)
    s_nop 0
    v_mfma_f32_16x16x32_bf16 v[124:127], v[28:31], v[48:51], v[124:127]
    ds_read_b128 v[96:99], v6 offset:1728
    v_mfma_f32_16x16x32_bf16 v[128:131], v[28:31], v[52:55], v[128:131]
    v_mfma_f32_16x16x32_bf16 v[132:135], v[28:31], v[56:59], v[132:135]
    ds_read_b128 v[100:103], v6 offset:1216
    v_mfma_f32_16x16x32_bf16 v[136:139], v[28:31], v[60:63], v[136:139]
    v_mfma_f32_16x16x32_bf16 v[140:143], v[28:31], v[64:67], v[140:143]
    ds_read_b128 v[28:31], v5 offset:1664
    s_waitcnt lgkmcnt(13)
    s_nop 0
    v_mfma_f32_16x16x32_bf16 v[120:123], v[24:27], v[48:51], v[120:123]
    ds_read_b128 v[104:107], v6 offset:704
    v_mfma_f32_16x16x32_bf16 v[124:127], v[24:27], v[52:55], v[124:127]
    v_mfma_f32_16x16x32_bf16 v[128:131], v[24:27], v[56:59], v[128:131]
    ds_read_b128 v[108:111], v6 offset:192
    v_mfma_f32_16x16x32_bf16 v[132:135], v[24:27], v[60:63], v[132:135]
    v_mfma_f32_16x16x32_bf16 v[136:139], v[24:27], v[64:67], v[136:139]
    v_mfma_f32_16x16x32_bf16 v[140:143], v[24:27], v[68:71], v[140:143]
    ds_read_b128 v[24:27], v5 offset:1152
    s_waitcnt lgkmcnt(15)
    s_nop 0
    v_mfma_f32_16x16x32_bf16 v[116:119], v[20:23], v[48:51], v[116:119]
    v_mfma_f32_16x16x32_bf16 v[120:123], v[20:23], v[52:55], v[120:123]
    v_mfma_f32_16x16x32_bf16 v[124:127], v[20:23], v[56:59], v[124:127]
    v_mfma_f32_16x16x32_bf16 v[128:131], v[20:23], v[60:63], v[128:131]
    v_mfma_f32_16x16x32_bf16 v[132:135], v[20:23], v[64:67], v[132:135]
    v_mfma_f32_16x16x32_bf16 v[136:139], v[20:23], v[68:71], v[136:139]
    v_mfma_f32_16x16x32_bf16 v[140:143], v[20:23], v[72:75], v[140:143]
    ds_read_b128 v[20:23], v5 offset:640
    s_waitcnt lgkmcnt(15)
    s_nop 0
    v_mfma_f32_16x16x32_bf16 v[112:115], v[16:19], v[48:51], v[112:115]
    v_mfma_f32_16x16x32_bf16 v[116:119], v[16:19], v[52:55], v[116:119]
    v_mfma_f32_16x16x32_bf16 v[120:123], v[16:19], v[56:59], v[120:123]
    v_mfma_f32_16x16x32_bf16 v[124:127], v[16:19], v[60:63], v[124:127]
    v_mfma_f32_16x16x32_bf16 v[128:131], v[16:19], v[64:67], v[128:131]
    v_mfma_f32_16x16x32_bf16 v[132:135], v[16:19], v[68:71], v[132:135]
    v_mfma_f32_16x16x32_bf16 v[136:139], v[16:19], v[72:75], v[136:139]
    v_mfma_f32_16x16x32_bf16 v[140:143], v[16:19], v[76:79], v[140:143]
    ds_read_b128 v[16:19], v5 offset:128
    s_waitcnt lgkmcnt(13)
    s_nop 0
    v_mfma_f32_16x16x32_bf16 v[140:143], v[44:47], v[80:83], v[140:143]
    ds_read_b128 v[44:47], v5 offset:3776
    v_mfma_f32_16x16x32_bf16 v[136:139], v[40:43], v[80:83], v[136:139]
    s_waitcnt lgkmcnt(13)
    s_nop 0
    v_mfma_f32_16x16x32_bf16 v[140:143], v[40:43], v[84:87], v[140:143]
    ds_read_b128 v[40:43], v5 offset:3264
    s_waitcnt lgkmcnt(13)
    s_nop 0
    v_mfma_f32_16x16x32_bf16 v[132:135], v[36:39], v[80:83], v[132:135]
    ds_read_b128 v[48:51], v6 offset:3840
    v_mfma_f32_16x16x32_bf16 v[136:139], v[36:39], v[84:87], v[136:139]
    s_waitcnt lgkmcnt(13)
    s_nop 0
    v_mfma_f32_16x16x32_bf16 v[140:143], v[36:39], v[88:91], v[140:143]
    ds_read_b128 v[52:55], v6 offset:3328
    ds_read_b128 v[36:39], v5 offset:2752
    s_waitcnt lgkmcnt(13)
    s_nop 0
    v_mfma_f32_16x16x32_bf16 v[128:131], v[32:35], v[80:83], v[128:131]
    ds_read_b128 v[56:59], v6 offset:2816
    v_mfma_f32_16x16x32_bf16 v[132:135], v[32:35], v[84:87], v[132:135]
    v_mfma_f32_16x16x32_bf16 v[136:139], v[32:35], v[88:91], v[136:139]
    ds_read_b128 v[60:63], v6 offset:2304
    v_mfma_f32_16x16x32_bf16 v[140:143], v[32:35], v[92:95], v[140:143]
    ds_read_b128 v[32:35], v5 offset:2240
    s_waitcnt lgkmcnt(13)
    s_nop 0
    v_mfma_f32_16x16x32_bf16 v[124:127], v[28:31], v[80:83], v[124:127]
    ds_read_b128 v[64:67], v6 offset:1792
    v_mfma_f32_16x16x32_bf16 v[128:131], v[28:31], v[84:87], v[128:131]
    v_mfma_f32_16x16x32_bf16 v[132:135], v[28:31], v[88:91], v[132:135]
    ds_read_b128 v[68:71], v6 offset:1280
    v_mfma_f32_16x16x32_bf16 v[136:139], v[28:31], v[92:95], v[136:139]
    v_mfma_f32_16x16x32_bf16 v[140:143], v[28:31], v[96:99], v[140:143]
    ds_read_b128 v[28:31], v5 offset:1728
    s_waitcnt lgkmcnt(13)
    s_nop 0
    v_mfma_f32_16x16x32_bf16 v[120:123], v[24:27], v[80:83], v[120:123]
    ds_read_b128 v[72:75], v6 offset:768
    v_mfma_f32_16x16x32_bf16 v[124:127], v[24:27], v[84:87], v[124:127]
    v_mfma_f32_16x16x32_bf16 v[128:131], v[24:27], v[88:91], v[128:131]
    ds_read_b128 v[76:79], v6 offset:256
    v_mfma_f32_16x16x32_bf16 v[132:135], v[24:27], v[92:95], v[132:135]
    v_mfma_f32_16x16x32_bf16 v[136:139], v[24:27], v[96:99], v[136:139]
    v_mfma_f32_16x16x32_bf16 v[140:143], v[24:27], v[100:103], v[140:143]
    ds_read_b128 v[24:27], v5 offset:1216
    s_waitcnt lgkmcnt(15)
    s_nop 0
    v_mfma_f32_16x16x32_bf16 v[116:119], v[20:23], v[80:83], v[116:119]
    v_mfma_f32_16x16x32_bf16 v[120:123], v[20:23], v[84:87], v[120:123]
    v_mfma_f32_16x16x32_bf16 v[124:127], v[20:23], v[88:91], v[124:127]
    v_mfma_f32_16x16x32_bf16 v[128:131], v[20:23], v[92:95], v[128:131]
    v_mfma_f32_16x16x32_bf16 v[132:135], v[20:23], v[96:99], v[132:135]
    v_mfma_f32_16x16x32_bf16 v[136:139], v[20:23], v[100:103], v[136:139]
    v_mfma_f32_16x16x32_bf16 v[140:143], v[20:23], v[104:107], v[140:143]
    ds_read_b128 v[20:23], v5 offset:704
    s_waitcnt lgkmcnt(15)
    s_nop 0
    v_mfma_f32_16x16x32_bf16 v[112:115], v[16:19], v[80:83], v[112:115]
    v_mfma_f32_16x16x32_bf16 v[116:119], v[16:19], v[84:87], v[116:119]
    v_mfma_f32_16x16x32_bf16 v[120:123], v[16:19], v[88:91], v[120:123]
    v_mfma_f32_16x16x32_bf16 v[124:127], v[16:19], v[92:95], v[124:127]
    v_mfma_f32_16x16x32_bf16 v[128:131], v[16:19], v[96:99], v[128:131]
    v_mfma_f32_16x16x32_bf16 v[132:135], v[16:19], v[100:103], v[132:135]
    v_mfma_f32_16x16x32_bf16 v[136:139], v[16:19], v[104:107], v[136:139]
    v_mfma_f32_16x16x32_bf16 v[140:143], v[16:19], v[108:111], v[140:143]
    ds_read_b128 v[16:19], v5 offset:192
    s_waitcnt lgkmcnt(13)
    s_nop 0
    v_mfma_f32_16x16x32_bf16 v[140:143], v[44:47], v[48:51], v[140:143]
    ds_read_b128 v[44:47], v5 offset:3840
    v_mfma_f32_16x16x32_bf16 v[136:139], v[40:43], v[48:51], v[136:139]
    s_waitcnt lgkmcnt(13)
    s_nop 0
    v_mfma_f32_16x16x32_bf16 v[140:143], v[40:43], v[52:55], v[140:143]
    ds_read_b128 v[40:43], v5 offset:3328
    s_waitcnt lgkmcnt(13)
    s_nop 0
    v_mfma_f32_16x16x32_bf16 v[132:135], v[36:39], v[48:51], v[132:135]
    ds_read_b128 v[80:83], v6 offset:3904
    v_mfma_f32_16x16x32_bf16 v[136:139], v[36:39], v[52:55], v[136:139]
    s_waitcnt lgkmcnt(13)
    s_nop 0
    v_mfma_f32_16x16x32_bf16 v[140:143], v[36:39], v[56:59], v[140:143]
    ds_read_b128 v[84:87], v6 offset:3392
    ds_read_b128 v[36:39], v5 offset:2816
    s_waitcnt lgkmcnt(13)
    s_nop 0
    v_mfma_f32_16x16x32_bf16 v[128:131], v[32:35], v[48:51], v[128:131]
    ds_read_b128 v[88:91], v6 offset:2880
    v_mfma_f32_16x16x32_bf16 v[132:135], v[32:35], v[52:55], v[132:135]
    v_mfma_f32_16x16x32_bf16 v[136:139], v[32:35], v[56:59], v[136:139]
    ds_read_b128 v[92:95], v6 offset:2368
    v_mfma_f32_16x16x32_bf16 v[140:143], v[32:35], v[60:63], v[140:143]
    ds_read_b128 v[32:35], v5 offset:2304
    s_waitcnt lgkmcnt(13)
    s_nop 0
    v_mfma_f32_16x16x32_bf16 v[124:127], v[28:31], v[48:51], v[124:127]
    ds_read_b128 v[96:99], v6 offset:1856
    v_mfma_f32_16x16x32_bf16 v[128:131], v[28:31], v[52:55], v[128:131]
    v_mfma_f32_16x16x32_bf16 v[132:135], v[28:31], v[56:59], v[132:135]
    ds_read_b128 v[100:103], v6 offset:1344
    v_mfma_f32_16x16x32_bf16 v[136:139], v[28:31], v[60:63], v[136:139]
    v_mfma_f32_16x16x32_bf16 v[140:143], v[28:31], v[64:67], v[140:143]
    ds_read_b128 v[28:31], v5 offset:1792
    s_waitcnt lgkmcnt(13)
    s_nop 0
    v_mfma_f32_16x16x32_bf16 v[120:123], v[24:27], v[48:51], v[120:123]
    ds_read_b128 v[104:107], v6 offset:832
    v_mfma_f32_16x16x32_bf16 v[124:127], v[24:27], v[52:55], v[124:127]
    v_mfma_f32_16x16x32_bf16 v[128:131], v[24:27], v[56:59], v[128:131]
    ds_read_b128 v[108:111], v6 offset:320
    v_mfma_f32_16x16x32_bf16 v[132:135], v[24:27], v[60:63], v[132:135]
    v_mfma_f32_16x16x32_bf16 v[136:139], v[24:27], v[64:67], v[136:139]
    v_mfma_f32_16x16x32_bf16 v[140:143], v[24:27], v[68:71], v[140:143]
    ds_read_b128 v[24:27], v5 offset:1280
    s_waitcnt lgkmcnt(15)
    s_nop 0
    v_mfma_f32_16x16x32_bf16 v[116:119], v[20:23], v[48:51], v[116:119]
    v_mfma_f32_16x16x32_bf16 v[120:123], v[20:23], v[52:55], v[120:123]
    v_mfma_f32_16x16x32_bf16 v[124:127], v[20:23], v[56:59], v[124:127]
    v_mfma_f32_16x16x32_bf16 v[128:131], v[20:23], v[60:63], v[128:131]
    v_mfma_f32_16x16x32_bf16 v[132:135], v[20:23], v[64:67], v[132:135]
    v_mfma_f32_16x16x32_bf16 v[136:139], v[20:23], v[68:71], v[136:139]
    v_mfma_f32_16x16x32_bf16 v[140:143], v[20:23], v[72:75], v[140:143]
    ds_read_b128 v[20:23], v5 offset:768
    s_waitcnt lgkmcnt(15)
    s_nop 0
    v_mfma_f32_16x16x32_bf16 v[112:115], v[16:19], v[48:51], v[112:115]
    v_mfma_f32_16x16x32_bf16 v[116:119], v[16:19], v[52:55], v[116:119]
    v_mfma_f32_16x16x32_bf16 v[120:123], v[16:19], v[56:59], v[120:123]
    v_mfma_f32_16x16x32_bf16 v[124:127], v[16:19], v[60:63], v[124:127]
    v_mfma_f32_16x16x32_bf16 v[128:131], v[16:19], v[64:67], v[128:131]
    v_mfma_f32_16x16x32_bf16 v[132:135], v[16:19], v[68:71], v[132:135]
    v_mfma_f32_16x16x32_bf16 v[136:139], v[16:19], v[72:75], v[136:139]
    v_mfma_f32_16x16x32_bf16 v[140:143], v[16:19], v[76:79], v[140:143]
    ds_read_b128 v[16:19], v5 offset:256
    s_waitcnt lgkmcnt(13)
    s_nop 0
    v_mfma_f32_16x16x32_bf16 v[140:143], v[44:47], v[80:83], v[140:143]
    ds_read_b128 v[44:47], v5 offset:3904
    v_mfma_f32_16x16x32_bf16 v[136:139], v[40:43], v[80:83], v[136:139]
    s_waitcnt lgkmcnt(13)
    s_nop 0
    v_mfma_f32_16x16x32_bf16 v[140:143], v[40:43], v[84:87], v[140:143]
    ds_read_b128 v[40:43], v5 offset:3392
    s_waitcnt lgkmcnt(13)
    s_nop 0
    v_mfma_f32_16x16x32_bf16 v[132:135], v[36:39], v[80:83], v[132:135]
    ds_read_b128 v[48:51], v6 offset:3968
    v_mfma_f32_16x16x32_bf16 v[136:139], v[36:39], v[84:87], v[136:139]
    s_waitcnt lgkmcnt(13)
    s_nop 0
    v_mfma_f32_16x16x32_bf16 v[140:143], v[36:39], v[88:91], v[140:143]
    ds_read_b128 v[52:55], v6 offset:3456
    ds_read_b128 v[36:39], v5 offset:2880
    s_waitcnt lgkmcnt(13)
    s_nop 0
    v_mfma_f32_16x16x32_bf16 v[128:131], v[32:35], v[80:83], v[128:131]
    ds_read_b128 v[56:59], v6 offset:2944
    v_mfma_f32_16x16x32_bf16 v[132:135], v[32:35], v[84:87], v[132:135]
    v_mfma_f32_16x16x32_bf16 v[136:139], v[32:35], v[88:91], v[136:139]
    ds_read_b128 v[60:63], v6 offset:2432
    v_mfma_f32_16x16x32_bf16 v[140:143], v[32:35], v[92:95], v[140:143]
    ds_read_b128 v[32:35], v5 offset:2368
    s_waitcnt lgkmcnt(13)
    s_nop 0
    v_mfma_f32_16x16x32_bf16 v[124:127], v[28:31], v[80:83], v[124:127]
    ds_read_b128 v[64:67], v6 offset:1920
    v_mfma_f32_16x16x32_bf16 v[128:131], v[28:31], v[84:87], v[128:131]
    v_mfma_f32_16x16x32_bf16 v[132:135], v[28:31], v[88:91], v[132:135]
    ds_read_b128 v[68:71], v6 offset:1408
    v_mfma_f32_16x16x32_bf16 v[136:139], v[28:31], v[92:95], v[136:139]
    v_mfma_f32_16x16x32_bf16 v[140:143], v[28:31], v[96:99], v[140:143]
    ds_read_b128 v[28:31], v5 offset:1856
    s_waitcnt lgkmcnt(13)
    s_nop 0
    v_mfma_f32_16x16x32_bf16 v[120:123], v[24:27], v[80:83], v[120:123]
    ds_read_b128 v[72:75], v6 offset:896
    v_mfma_f32_16x16x32_bf16 v[124:127], v[24:27], v[84:87], v[124:127]
    v_mfma_f32_16x16x32_bf16 v[128:131], v[24:27], v[88:91], v[128:131]
    ds_read_b128 v[76:79], v6 offset:384
    v_mfma_f32_16x16x32_bf16 v[132:135], v[24:27], v[92:95], v[132:135]
    v_mfma_f32_16x16x32_bf16 v[136:139], v[24:27], v[96:99], v[136:139]
    v_mfma_f32_16x16x32_bf16 v[140:143], v[24:27], v[100:103], v[140:143]
    ds_read_b128 v[24:27], v5 offset:1344
    s_waitcnt lgkmcnt(15)
    s_nop 0
    v_mfma_f32_16x16x32_bf16 v[116:119], v[20:23], v[80:83], v[116:119]
    v_mfma_f32_16x16x32_bf16 v[120:123], v[20:23], v[84:87], v[120:123]
    v_mfma_f32_16x16x32_bf16 v[124:127], v[20:23], v[88:91], v[124:127]
    v_mfma_f32_16x16x32_bf16 v[128:131], v[20:23], v[92:95], v[128:131]
    v_mfma_f32_16x16x32_bf16 v[132:135], v[20:23], v[96:99], v[132:135]
    v_mfma_f32_16x16x32_bf16 v[136:139], v[20:23], v[100:103], v[136:139]
    v_mfma_f32_16x16x32_bf16 v[140:143], v[20:23], v[104:107], v[140:143]
    ds_read_b128 v[20:23], v5 offset:832
    s_waitcnt lgkmcnt(15)
    s_nop 0
    v_mfma_f32_16x16x32_bf16 v[112:115], v[16:19], v[80:83], v[112:115]
    v_mfma_f32_16x16x32_bf16 v[116:119], v[16:19], v[84:87], v[116:119]
    v_mfma_f32_16x16x32_bf16 v[120:123], v[16:19], v[88:91], v[120:123]
    v_mfma_f32_16x16x32_bf16 v[124:127], v[16:19], v[92:95], v[124:127]
    v_mfma_f32_16x16x32_bf16 v[128:131], v[16:19], v[96:99], v[128:131]
    v_mfma_f32_16x16x32_bf16 v[132:135], v[16:19], v[100:103], v[132:135]
    v_mfma_f32_16x16x32_bf16 v[136:139], v[16:19], v[104:107], v[136:139]
    v_mfma_f32_16x16x32_bf16 v[140:143], v[16:19], v[108:111], v[140:143]
    ds_read_b128 v[16:19], v5 offset:320
    s_waitcnt lgkmcnt(13)
    s_nop 0
    v_mfma_f32_16x16x32_bf16 v[140:143], v[44:47], v[48:51], v[140:143]
    ds_read_b128 v[44:47], v5 offset:3968
    v_mfma_f32_16x16x32_bf16 v[136:139], v[40:43], v[48:51], v[136:139]
    s_waitcnt lgkmcnt(13)
    s_nop 0
    v_mfma_f32_16x16x32_bf16 v[140:143], v[40:43], v[52:55], v[140:143]
    ds_read_b128 v[40:43], v5 offset:3456
    s_waitcnt lgkmcnt(13)
    s_nop 0
    v_mfma_f32_16x16x32_bf16 v[132:135], v[36:39], v[48:51], v[132:135]
    ds_read_b128 v[80:83], v6 offset:4032
    v_mfma_f32_16x16x32_bf16 v[136:139], v[36:39], v[52:55], v[136:139]
    s_waitcnt lgkmcnt(13)
    s_nop 0
    v_mfma_f32_16x16x32_bf16 v[140:143], v[36:39], v[56:59], v[140:143]
    ds_read_b128 v[84:87], v6 offset:3520
    ds_read_b128 v[36:39], v5 offset:2944
    s_waitcnt lgkmcnt(13)
    s_nop 0
    v_mfma_f32_16x16x32_bf16 v[128:131], v[32:35], v[48:51], v[128:131]
    ds_read_b128 v[88:91], v6 offset:3008
    v_mfma_f32_16x16x32_bf16 v[132:135], v[32:35], v[52:55], v[132:135]
    v_mfma_f32_16x16x32_bf16 v[136:139], v[32:35], v[56:59], v[136:139]
    ds_read_b128 v[92:95], v6 offset:2496
    v_mfma_f32_16x16x32_bf16 v[140:143], v[32:35], v[60:63], v[140:143]
    ds_read_b128 v[32:35], v5 offset:2432
    s_waitcnt lgkmcnt(13)
    s_nop 0
    v_mfma_f32_16x16x32_bf16 v[124:127], v[28:31], v[48:51], v[124:127]
    ds_read_b128 v[96:99], v6 offset:1984
    v_mfma_f32_16x16x32_bf16 v[128:131], v[28:31], v[52:55], v[128:131]
    v_mfma_f32_16x16x32_bf16 v[132:135], v[28:31], v[56:59], v[132:135]
    ds_read_b128 v[100:103], v6 offset:1472
    v_mfma_f32_16x16x32_bf16 v[136:139], v[28:31], v[60:63], v[136:139]
    v_mfma_f32_16x16x32_bf16 v[140:143], v[28:31], v[64:67], v[140:143]
    ds_read_b128 v[28:31], v5 offset:1920
    s_waitcnt lgkmcnt(13)
    s_nop 0
    v_mfma_f32_16x16x32_bf16 v[120:123], v[24:27], v[48:51], v[120:123]
    ds_read_b128 v[104:107], v6 offset:960
    v_mfma_f32_16x16x32_bf16 v[124:127], v[24:27], v[52:55], v[124:127]
    v_mfma_f32_16x16x32_bf16 v[128:131], v[24:27], v[56:59], v[128:131]
    ds_read_b128 v[108:111], v6 offset:448
    v_mfma_f32_16x16x32_bf16 v[132:135], v[24:27], v[60:63], v[132:135]
    v_mfma_f32_16x16x32_bf16 v[136:139], v[24:27], v[64:67], v[136:139]
    v_mfma_f32_16x16x32_bf16 v[140:143], v[24:27], v[68:71], v[140:143]
    ds_read_b128 v[24:27], v5 offset:1408
    s_waitcnt lgkmcnt(15)
    s_nop 0
    v_mfma_f32_16x16x32_bf16 v[116:119], v[20:23], v[48:51], v[116:119]
    v_mfma_f32_16x16x32_bf16 v[120:123], v[20:23], v[52:55], v[120:123]
    v_mfma_f32_16x16x32_bf16 v[124:127], v[20:23], v[56:59], v[124:127]
    v_mfma_f32_16x16x32_bf16 v[128:131], v[20:23], v[60:63], v[128:131]
    v_mfma_f32_16x16x32_bf16 v[132:135], v[20:23], v[64:67], v[132:135]
    v_mfma_f32_16x16x32_bf16 v[136:139], v[20:23], v[68:71], v[136:139]
    v_mfma_f32_16x16x32_bf16 v[140:143], v[20:23], v[72:75], v[140:143]
    ds_read_b128 v[20:23], v5 offset:896
    s_waitcnt lgkmcnt(15)
    s_nop 0
    v_mfma_f32_16x16x32_bf16 v[112:115], v[16:19], v[48:51], v[112:115]
    v_mfma_f32_16x16x32_bf16 v[116:119], v[16:19], v[52:55], v[116:119]
    v_mfma_f32_16x16x32_bf16 v[120:123], v[16:19], v[56:59], v[120:123]
    v_mfma_f32_16x16x32_bf16 v[124:127], v[16:19], v[60:63], v[124:127]
    v_mfma_f32_16x16x32_bf16 v[128:131], v[16:19], v[64:67], v[128:131]
    v_mfma_f32_16x16x32_bf16 v[132:135], v[16:19], v[68:71], v[132:135]
    v_mfma_f32_16x16x32_bf16 v[136:139], v[16:19], v[72:75], v[136:139]
    v_mfma_f32_16x16x32_bf16 v[140:143], v[16:19], v[76:79], v[140:143]
    ds_read_b128 v[16:19], v5 offset:384
    s_waitcnt lgkmcnt(13)
    s_nop 0
    v_mfma_f32_16x16x32_bf16 v[140:143], v[44:47], v[80:83], v[140:143]
    v_mfma_f32_16x16x32_bf16 v[136:139], v[40:43], v[80:83], v[136:139]
    s_waitcnt lgkmcnt(12)
    s_nop 0
    v_mfma_f32_16x16x32_bf16 v[140:143], v[40:43], v[84:87], v[140:143]
    s_waitcnt lgkmcnt(11)
    s_nop 0
    v_mfma_f32_16x16x32_bf16 v[132:135], v[36:39], v[80:83], v[132:135]
    v_mfma_f32_16x16x32_bf16 v[136:139], v[36:39], v[84:87], v[136:139]
    s_waitcnt lgkmcnt(10)
    s_nop 0
    v_mfma_f32_16x16x32_bf16 v[140:143], v[36:39], v[88:91], v[140:143]
    s_waitcnt lgkmcnt(8)
    s_nop 0
    v_mfma_f32_16x16x32_bf16 v[128:131], v[32:35], v[80:83], v[128:131]
    v_mfma_f32_16x16x32_bf16 v[132:135], v[32:35], v[84:87], v[132:135]
    v_mfma_f32_16x16x32_bf16 v[136:139], v[32:35], v[88:91], v[136:139]
    v_mfma_f32_16x16x32_bf16 v[140:143], v[32:35], v[92:95], v[140:143]
    s_waitcnt lgkmcnt(5)
    s_nop 0
    v_mfma_f32_16x16x32_bf16 v[124:127], v[28:31], v[80:83], v[124:127]
    v_mfma_f32_16x16x32_bf16 v[128:131], v[28:31], v[84:87], v[128:131]
    v_mfma_f32_16x16x32_bf16 v[132:135], v[28:31], v[88:91], v[132:135]
    v_mfma_f32_16x16x32_bf16 v[136:139], v[28:31], v[92:95], v[136:139]
    v_mfma_f32_16x16x32_bf16 v[140:143], v[28:31], v[96:99], v[140:143]
    s_waitcnt lgkmcnt(2)
    s_nop 0
    v_mfma_f32_16x16x32_bf16 v[120:123], v[24:27], v[80:83], v[120:123]
    v_mfma_f32_16x16x32_bf16 v[124:127], v[24:27], v[84:87], v[124:127]
    v_mfma_f32_16x16x32_bf16 v[128:131], v[24:27], v[88:91], v[128:131]
    v_mfma_f32_16x16x32_bf16 v[132:135], v[24:27], v[92:95], v[132:135]
    v_mfma_f32_16x16x32_bf16 v[136:139], v[24:27], v[96:99], v[136:139]
    v_mfma_f32_16x16x32_bf16 v[140:143], v[24:27], v[100:103], v[140:143]
    s_waitcnt lgkmcnt(1)
    s_nop 0
    v_mfma_f32_16x16x32_bf16 v[116:119], v[20:23], v[80:83], v[116:119]
    v_mfma_f32_16x16x32_bf16 v[120:123], v[20:23], v[84:87], v[120:123]
    v_mfma_f32_16x16x32_bf16 v[124:127], v[20:23], v[88:91], v[124:127]
    v_mfma_f32_16x16x32_bf16 v[128:131], v[20:23], v[92:95], v[128:131]
    v_mfma_f32_16x16x32_bf16 v[132:135], v[20:23], v[96:99], v[132:135]
    v_mfma_f32_16x16x32_bf16 v[136:139], v[20:23], v[100:103], v[136:139]
    v_mfma_f32_16x16x32_bf16 v[140:143], v[20:23], v[104:107], v[140:143]
    s_waitcnt lgkmcnt(0)
    s_nop 0
    v_mfma_f32_16x16x32_bf16 v[112:115], v[16:19], v[80:83], v[112:115]
    v_mfma_f32_16x16x32_bf16 v[116:119], v[16:19], v[84:87], v[116:119]
    v_mfma_f32_16x16x32_bf16 v[120:123], v[16:19], v[88:91], v[120:123]
    v_mfma_f32_16x16x32_bf16 v[124:127], v[16:19], v[92:95], v[124:127]
    v_mfma_f32_16x16x32_bf16 v[128:131], v[16:19], v[96:99], v[128:131]
    v_mfma_f32_16x16x32_bf16 v[132:135], v[16:19], v[100:103], v[132:135]
    v_mfma_f32_16x16x32_bf16 v[136:139], v[16:19], v[104:107], v[136:139]
    v_mfma_f32_16x16x32_bf16 v[140:143], v[16:19], v[108:111], v[140:143]
    s_nop 7
    v_cvt_pk_bf16_f32 v16, v112, v113
    v_cvt_pk_bf16_f32 v17, v114, v115
    ds_write_b64 v7, v[16:17] offset:0
    v_cvt_pk_bf16_f32 v18, v116, v117
    v_cvt_pk_bf16_f32 v19, v118, v119
    ds_write_b64 v7, v[18:19] offset:512
    v_cvt_pk_bf16_f32 v20, v120, v121
    v_cvt_pk_bf16_f32 v21, v122, v123
    ds_write_b64 v7, v[20:21] offset:1024
    v_cvt_pk_bf16_f32 v22, v124, v125
    v_cvt_pk_bf16_f32 v23, v126, v127
    ds_write_b64 v7, v[22:23] offset:1536
    v_cvt_pk_bf16_f32 v24, v128, v129
    v_cvt_pk_bf16_f32 v25, v130, v131
    ds_write_b64 v7, v[24:25] offset:2048
    v_cvt_pk_bf16_f32 v26, v132, v133
    v_cvt_pk_bf16_f32 v27, v134, v135
    ds_write_b64 v7, v[26:27] offset:2560
    v_cvt_pk_bf16_f32 v28, v136, v137
    v_cvt_pk_bf16_f32 v29, v138, v139
    ds_write_b64 v7, v[28:29] offset:3072
    v_cvt_pk_bf16_f32 v30, v140, v141
    v_cvt_pk_bf16_f32 v31, v142, v143
    ds_write_b64 v7, v[30:31] offset:3584
    v_lshlrev_b32 v8, 2, v0
    v_add_u32 v9, 51840, v8
    v_lshrrev_b32 v10, 3, v0
    v_lshlrev_b32 v10, 15, v10
    v_and_b32 v11, 7, v0
    v_lshl_add_u32 v10, v11, 4, v10
    s_mov_b32 s28, 0x05040100
    s_mov_b32 s29, 0x07060302
    s_mov_b32 s51, 0x100000
    s_mov_b32 s52, 0x200000
    s_mov_b32 s53, 0x300000
    s_waitcnt lgkmcnt(0)
    s_barrier
    ds_read_b32 v32, v8 offset:0
    ds_read_b32 v33, v8 offset:25920
    ds_read_b32 v34, v9 offset:0
    ds_read_b32 v35, v9 offset:25920
    ds_read_b32 v36, v8 offset:1024
    ds_read_b32 v37, v8 offset:26944
    ds_read_b32 v38, v9 offset:1024
    ds_read_b32 v39, v9 offset:26944
    ds_read_b32 v40, v8 offset:2048
    ds_read_b32 v41, v8 offset:27968
    ds_read_b32 v42, v9 offset:2048
    ds_read_b32 v43, v9 offset:27968
    ds_read_b32 v44, v8 offset:3072
    ds_read_b32 v45, v8 offset:28992
    ds_read_b32 v46, v9 offset:3072
    ds_read_b32 v47, v9 offset:28992
    s_waitcnt lgkmcnt(12)
    v_perm_b32 v48, v33, v32, s28
    v_perm_b32 v49, v35, v34, s28
    v_perm_b32 v50, v33, v32, s29
    v_perm_b32 v51, v35, v34, s29
    buffer_store_dwordx4 v[48:51], v10, s[24:27], 0 offen sc1
    s_waitcnt lgkmcnt(8)
    v_perm_b32 v52, v37, v36, s28
    v_perm_b32 v53, v39, v38, s28
    v_perm_b32 v54, v37, v36, s29
    v_perm_b32 v55, v39, v38, s29
    buffer_store_dwordx4 v[52:55], v10, s[24:27], s51 offen sc1
    s_waitcnt lgkmcnt(4)
    v_perm_b32 v56, v41, v40, s28
    v_perm_b32 v57, v43, v42, s28
    v_perm_b32 v58, v41, v40, s29
    v_perm_b32 v59, v43, v42, s29
    buffer_store_dwordx4 v[56:59], v10, s[24:27], s52 offen sc1
    s_waitcnt lgkmcnt(0)
    v_perm_b32 v60, v45, v44, s28
    v_perm_b32 v61, v47, v46, s28
    v_perm_b32 v62, v45, v44, s29
    v_perm_b32 v63, v47, v46, s29
    buffer_store_dwordx4 v[60:63], v10, s[24:27], s53 offen sc1
    s_setprio 0
Lf_join:
    s_waitcnt vmcnt(0)
Lf_join2:
    s_barrier
    v_readfirstlane_b32 s3, v0
    s_nop 3
    s_cmp_lg_u32 s3, 0
    s_cbranch_scc1 Lr1_nh0
    s_add_u32 s64, s6, 58720256
    s_addc_u32 s65, s7, 0
    s_and_b32 s65, s65, 0xffff
    s_mov_b32 s66, 262144
    s_mov_b32 s67, 0x20000
    v_and_b32 v80, 63, v0
    v_mov_b32 v86, s72
    v_mov_b32 v87, s73
    v_mov_b32 v82, 0
    s_lshl_b32 s68, s2, 10
    s_mov_b64 exec, 1
    buffer_store_dwordx2 v[86:87], v82, s[64:67], s68 offen offset:768 sc1
    s_mov_b64 exec, -1
Lr1_nh0:
    v_and_b32 v1, 63, v0
    v_lshrrev_b32 v2, 6, v0
    s_lshl_b32 s3, s2, 14
    v_lshlrev_b32 v3, 11, v2
    v_lshl_add_u32 v3, v1, 4, v3
    v_add_u32 v3, s3, v3
    s_lshr_b32 s28, s2, 1
    s_lshl_b32 s28, s28, 15
    s_and_b32 s29, s2, 1
    s_lshl_b32 s30, s29, 6
    s_add_u32 s28, s28, s30
    s_add_u32 s28, s28, 14680064
    v_lshrrev_b32 v5, 2, v0
    v_and_b32 v6, 3, v0
    v_lshlrev_b32 v4, 7, v5
    v_lshl_add_u32 v4, v6, 4, v4
    s_movk_i32 s22, 0x4000
    s_waitcnt lgkmcnt(0)
    s_add_u32 s12, s6, s28
    s_addc_u32 s13, s7, 0
    s_and_b32 s13, s13, 0xffff
    s_mov_b32 s14, 32704
    s_mov_b32 s15, 0x20000
    s_movk_i32 s36, 0x4000
    v_mov_b32 v14, v4
    v_mov_b32 v16, v200
    v_mov_b32 v17, v201
    v_mov_b32 v18, v202
    v_mov_b32 v19, v203
    v_mov_b32 v20, v204
    v_mov_b32 v21, v205
    v_mov_b32 v22, v206
    v_mov_b32 v23, v207
    s_add_u32 s16, s6, 18874368
    s_addc_u32 s17, s7, 0
    s_and_b32 s17, s17, 0xffff
    s_mov_b32 s18, 4194304
    s_mov_b32 s19, 0x20000
    s_lshr_b32 s28, s2, 4
    s_lshl_b32 s28, s28, 18
    s_bfe_u32 s30, s2, 0x30001
    s_lshl_b32 s30, s30, 10
    s_add_u32 s28, s28, s30
    s_lshl_b32 s30, s29, 7
    s_add_u32 s28, s28, s30
    s_add_u32 s28, s28, 23068672
    s_add_u32 s24, s6, s28
    s_addc_u32 s25, s7, 0
    s_and_b32 s25, s25, 0xffff
    s_mov_b32 s26, 262144
    s_mov_b32 s27, 0x20000
    v_mul_u32_u24 v6, 4128, v6
    v_lshl_add_u32 v5, v5, 3, v6
    v_lshrrev_b32 v6, 1, v2
    v_and_b32 v7, 1, v2
    v_lshl_add_u32 v6, v7, 2, v6
    v_mul_u32_u24 v6, 2064, v6
    v_lshl_add_u32 v6, v1, 4, v6
    v_mul_u32_u24 v7, 2112, v2
    v_lshl_add_u32 v7, v1, 4, v7
    v_and_b32 v12, 7, v0
    v_lshrrev_b32 v13, 3, v0
    v_mul_u32_u24 v2, 2112, v12
    v_lshl_add_u32 v2, v13, 4, v2
    v_lshrrev_b32 v4, 2, v13
    v_lshlrev_b32 v4, 13, v4
    v_and_b32 v13, 3, v13
    v_lshl_add_u32 v4, v13, 8, v4
    v_lshl_add_u32 v4, v12, 4, v4
    s_mov_b32 s22, 0x20000
    v_add_u32 v5, 135680, v5
    v_add_u32 v6, 135680, v6
    v_add_u32 v7, 118784, v7
    v_add_u32 v2, 118784, v2
    s_mov_b32 s23, 0x3f803f80
    v_dot2_f32_bf16 v8, v16, s23, 0
    v_dot2_f32_bf16 v9, v16, v16, 0
    v_dot2_f32_bf16 v8, v17, s23, v8
    v_dot2_f32_bf16 v9, v17, v17, v9
    v_dot2_f32_bf16 v8, v18, s23, v8
    v_dot2_f32_bf16 v9, v18, v18, v9
    v_dot2_f32_bf16 v8, v19, s23, v8
    v_dot2_f32_bf16 v9, v19, v19, v9
    v_dot2_f32_bf16 v8, v20, s23, v8
    v_dot2_f32_bf16 v9, v20, v20, v9
    v_dot2_f32_bf16 v8, v21, s23, v8
    v_dot2_f32_bf16 v9, v21, v21, v9
    v_dot2_f32_bf16 v8, v22, s23, v8
    v_dot2_f32_bf16 v9, v22, v22, v9
    v_dot2_f32_bf16 v8, v23, s23, v8
    v_dot2_f32_bf16 v9, v23, v23, v9
    v_lshlrev_b32 v32, 16, v16
    v_and_b32 v33, 0xffff0000, v16
    v_lshlrev_b32 v34, 16, v17
    v_add_f32_dpp v8, v8, v8 row_shr:1 row_mask:0xf bank_mask:0xf bound_ctrl:0
    v_add_f32_dpp v9, v9, v9 row_shr:1 row_mask:0xf bank_mask:0xf bound_ctrl:0
    v_and_b32 v35, 0xffff0000, v17
    v_add_f32_dpp v8, v8, v8 row_shr:2 row_mask:0xf bank_mask:0xf bound_ctrl:0
    v_add_f32_dpp v9, v9, v9 row_shr:2 row_mask:0xf bank_mask:0xf bound_ctrl:0
    v_lshlrev_b32 v36, 16, v18
    v_add_f32_dpp v8, v8, v8 row_shr:4 row_mask:0xf bank_mask:0xf bound_ctrl:0
    v_add_f32_dpp v9, v9, v9 row_shr:4 row_mask:0xf bank_mask:0xf bound_ctrl:0
    v_and_b32 v37, 0xffff0000, v18
    v_add_f32_dpp v8, v8, v8 row_shr:8 row_mask:0xf bank_mask:0xf bound_ctrl:0
    v_add_f32_dpp v9, v9, v9 row_shr:8 row_mask:0xf bank_mask:0xf bound_ctrl:0
    v_lshlrev_b32 v38, 16, v19
    v_add_f32_dpp v8, v8, v8 row_bcast:15 row_mask:0xa bank_mask:0xf
    v_add_f32_dpp v9, v9, v9 row_bcast:15 row_mask:0xa bank_mask:0xf
    v_and_b32 v39, 0xffff0000, v19
    v_add_f32_dpp v8, v8, v8 row_bcast:31 row_mask:0xc bank_mask:0xf
    v_add_f32_dpp v9, v9, v9 row_bcast:31 row_mask:0xc bank_mask:0xf
    v_lshlrev_b32 v40, 16, v20
    v_readlane_b32 s20, v8, 63
    v_readlane_b32 s21, v9, 63
    v_mov_b32 v10, 0x3a800000
    v_and_b32 v41, 0xffff0000, v20
    v_mul_f32 v12, s20, v10
    v_mul_f32 v10, s21, v10
    v_fma_f32 v10, -v12, v12, v10
    v_max_f32 v10, 0, v10
    v_cvt_pk_bf16_f32 v10, v10, v10
    v_lshlrev_b32 v10, 16, v10
    v_cvt_pk_bf16_f32 v12, v12, v12
    v_lshlrev_b32 v12, 16, v12
    v_add_f32 v10, 0x3727c5ac, v10
    v_cvt_pk_bf16_f32 v10, v10, v10
    v_lshlrev_b32 v10, 16, v10
    v_sqrt_f32 v10, v10
    v_lshlrev_b32 v42, 16, v21
    v_cvt_pk_bf16_f32 v10, v10, v10
    v_lshlrev_b32 v10, 16, v10
    v_rcp_f32 v10, v10
    v_and_b32 v43, 0xffff0000, v21
    v_mul_f32 v12, v10, v12
    v_mov_b32 v11, v10
    v_sub_f32 v12, 0, v12
    v_mov_b32 v13, v12
    v_lshlrev_b32 v44, 16, v22
    v_and_b32 v45, 0xffff0000, v22
    v_lshlrev_b32 v46, 16, v23
    v_and_b32 v47, 0xffff0000, v23
    v_readfirstlane_b32 s3, v0
    s_nop 3
    s_cmp_lg_u32 s3, 0
    s_cbranch_scc1 Lr1_nh1
    s_add_u32 s64, s6, 58720256
    s_addc_u32 s65, s7, 0
    s_and_b32 s65, s65, 0xffff
    s_mov_b32 s66, 262144
    s_mov_b32 s67, 0x20000
    v_and_b32 v80, 63, v0
    s_and_b32 s69, s2, 0xf0
    s_lshl_b32 s69, s69, 10
    v_lshlrev_b32 v80, 10, v80
    s_mov_b64 exec, 0xffff
    s_mov_b32 s58, 0x40000
Lr12_hp:
    buffer_load_dwordx2 v[84:85], v80, s[64:67], s69 offen offset:768 sc1
    s_sub_u32 s58, s58, 1
    s_cbranch_scc1 Lr12_hg
    s_waitcnt vmcnt(0)
    v_cmp_ne_u64 vcc, s[72:73], v[84:85]
    s_cbranch_vccnz Lr12_hp
Lr12_hg:
    s_waitcnt vmcnt(0)
    s_mov_b64 exec, -1
    s_add_u32 s64, s6, 58720256
    s_addc_u32 s65, s7, 0
    s_and_b32 s65, s65, 0xffff
    s_mov_b32 s66, 262144
    s_mov_b32 s67, 0x20000
    v_and_b32 v80, 63, v0
    v_mov_b32 v86, s72
    v_mov_b32 v87, s73
    v_mov_b32 v82, 0
    s_lshl_b32 s68, s2, 10
    s_mov_b64 exec, 1
    buffer_store_dwordx2 v[86:87], v82, s[64:67], s68 offen offset:896 sc1
    s_mov_b64 exec, -1
    s_and_b32 s69, s2, 15
    s_lshl_b32 s69, s69, 10
    v_lshlrev_b32 v80, 14, v80
    s_mov_b64 exec, 0xffff
    s_mov_b32 s58, 0x40000
Lr13_hp:
    buffer_load_dwordx2 v[84:85], v80, s[64:67], s69 offen offset:896 sc1
    s_sub_u32 s58, s58, 1
    s_cbranch_scc1 Lr13_hg
    s_waitcnt vmcnt(0)
    v_cmp_ne_u64 vcc, s[72:73], v[84:85]
    s_cbranch_vccnz Lr13_hp
Lr13_hg:
    s_waitcnt vmcnt(0)
    s_mov_b64 exec, -1
Lr1_nh1:
    s_barrier
    buffer_load_dwordx4 v[24:27], v14, s[12:15], 0 offen
    buffer_load_dwordx4 v[28:31], v14, s[12:15], s36 offen
    s_waitcnt vmcnt(0)
    ds_write_b64 v5, v[24:25] offset:0
    ds_write_b64 v5, v[26:27] offset:2064
    ds_write_b64 v5, v[28:29] offset:1024
    ds_write_b64 v5, v[30:31] offset:3088
    s_waitcnt lgkmcnt(0)
    s_barrier
    ds_read_b128 v[232:235], v6
    ds_read_b128 v[236:239], v6 offset:1024
    s_waitcnt lgkmcnt(0)
    v_lshlrev_b32 v16, 16, v232
    v_and_b32 v17, 0xffff0000, v232
    v_pk_fma_f32 v[48:49], v[32:33], v[10:11], v[12:13]
    v_pk_fma_f32 v[32:33], v[48:49], v[16:17], v[32:33]
    v_lshlrev_b32 v18, 16, v233
    v_and_b32 v19, 0xffff0000, v233
    v_pk_fma_f32 v[50:51], v[34:35], v[10:11], v[12:13]
    v_pk_fma_f32 v[34:35], v[50:51], v[18:19], v[34:35]
    v_lshlrev_b32 v20, 16, v234
    v_and_b32 v21, 0xffff0000, v234
    v_pk_fma_f32 v[52:53], v[36:37], v[10:11], v[12:13]
    v_pk_fma_f32 v[36:37], v[52:53], v[20:21], v[36:37]
    v_lshlrev_b32 v22, 16, v235
    v_and_b32 v23, 0xffff0000, v235
    v_pk_fma_f32 v[54:55], v[38:39], v[10:11], v[12:13]
    v_pk_fma_f32 v[38:39], v[54:55], v[22:23], v[38:39]
    v_lshlrev_b32 v16, 16, v236
    v_and_b32 v17, 0xffff0000, v236
    v_pk_fma_f32 v[56:57], v[40:41], v[10:11], v[12:13]
    v_pk_fma_f32 v[40:41], v[56:57], v[16:17], v[40:41]
    v_lshlrev_b32 v18, 16, v237
    v_and_b32 v19, 0xffff0000, v237
    v_pk_fma_f32 v[58:59], v[42:43], v[10:11], v[12:13]
    v_pk_fma_f32 v[42:43], v[58:59], v[18:19], v[42:43]
    v_lshlrev_b32 v20, 16, v238
    v_and_b32 v21, 0xffff0000, v238
    v_pk_fma_f32 v[60:61], v[44:45], v[10:11], v[12:13]
    v_pk_fma_f32 v[44:45], v[60:61], v[20:21], v[44:45]
    v_lshlrev_b32 v22, 16, v239
    v_and_b32 v23, 0xffff0000, v239
    v_pk_fma_f32 v[62:63], v[46:47], v[10:11], v[12:13]
    v_pk_fma_f32 v[46:47], v[62:63], v[22:23], v[46:47]
    v_cvt_pk_bf16_f32 v240, v32, v33
    v_cvt_pk_bf16_f32 v241, v34, v35
    v_cvt_pk_bf16_f32 v242, v36, v37
    v_cvt_pk_bf16_f32 v243, v38, v39
    v_cvt_pk_bf16_f32 v244, v40, v41
    v_cvt_pk_bf16_f32 v245, v42, v43
    v_cvt_pk_bf16_f32 v246, v44, v45
    v_cvt_pk_bf16_f32 v247, v46, v47
    v_dot2_f32_bf16 v8, v240, s23, 0
    v_dot2_f32_bf16 v9, v240, v240, 0
    v_dot2_f32_bf16 v8, v241, s23, v8
    v_dot2_f32_bf16 v9, v241, v241, v9
    v_dot2_f32_bf16 v8, v242, s23, v8
    v_dot2_f32_bf16 v9, v242, v242, v9
    v_dot2_f32_bf16 v8, v243, s23, v8
    v_dot2_f32_bf16 v9, v243, v243, v9
    v_dot2_f32_bf16 v8, v244, s23, v8
    v_dot2_f32_bf16 v9, v244, v244, v9
    v_dot2_f32_bf16 v8, v245, s23, v8
    v_dot2_f32_bf16 v9, v245, v245, v9
    v_dot2_f32_bf16 v8, v246, s23, v8
    v_dot2_f32_bf16 v9, v246, v246, v9
    v_dot2_f32_bf16 v8, v247, s23, v8
    v_dot2_f32_bf16 v9, v247, v247, v9
    v_lshlrev_b32 v32, 16, v240
    v_and_b32 v33, 0xffff0000, v240
    v_lshlrev_b32 v34, 16, v241
    v_add_f32_dpp v8, v8, v8 row_shr:1 row_mask:0xf bank_mask:0xf bound_ctrl:0
    v_add_f32_dpp v9, v9, v9 row_shr:1 row_mask:0xf bank_mask:0xf bound_ctrl:0
    v_and_b32 v35, 0xffff0000, v241
    v_add_f32_dpp v8, v8, v8 row_shr:2 row_mask:0xf bank_mask:0xf bound_ctrl:0
    v_add_f32_dpp v9, v9, v9 row_shr:2 row_mask:0xf bank_mask:0xf bound_ctrl:0
    v_lshlrev_b32 v36, 16, v242
    v_add_f32_dpp v8, v8, v8 row_shr:4 row_mask:0xf bank_mask:0xf bound_ctrl:0
    v_add_f32_dpp v9, v9, v9 row_shr:4 row_mask:0xf bank_mask:0xf bound_ctrl:0
    v_and_b32 v37, 0xffff0000, v242
    v_add_f32_dpp v8, v8, v8 row_shr:8 row_mask:0xf bank_mask:0xf bound_ctrl:0
    v_add_f32_dpp v9, v9, v9 row_shr:8 row_mask:0xf bank_mask:0xf bound_ctrl:0
    v_lshlrev_b32 v38, 16, v243
    v_add_f32_dpp v8, v8, v8 row_bcast:15 row_mask:0xa bank_mask:0xf
    v_add_f32_dpp v9, v9, v9 row_bcast:15 row_mask:0xa bank_mask:0xf
    v_and_b32 v39, 0xffff0000, v243
    v_add_f32_dpp v8, v8, v8 row_bcast:31 row_mask:0xc bank_mask:0xf
    v_add_f32_dpp v9, v9, v9 row_bcast:31 row_mask:0xc bank_mask:0xf
    v_lshlrev_b32 v40, 16, v244
    v_readlane_b32 s20, v8, 63
    v_readlane_b32 s21, v9, 63
    v_mov_b32 v10, 0x3a800000
    v_and_b32 v41, 0xffff0000, v244
    v_mul_f32 v12, s20, v10
    v_mul_f32 v10, s21, v10
    v_fma_f32 v10, -v12, v12, v10
    v_max_f32 v10, 0, v10
    v_cvt_pk_bf16_f32 v10, v10, v10
    v_lshlrev_b32 v10, 16, v10
    v_cvt_pk_bf16_f32 v12, v12, v12
    v_lshlrev_b32 v12, 16, v12
    v_add_f32 v10, 0x3727c5ac, v10
    v_cvt_pk_bf16_f32 v10, v10, v10
    v_lshlrev_b32 v10, 16, v10
    v_sqrt_f32 v10, v10
    v_lshlrev_b32 v42, 16, v245
    v_cvt_pk_bf16_f32 v10, v10, v10
    v_lshlrev_b32 v10, 16, v10
    v_rcp_f32 v10, v10
    v_and_b32 v43, 0xffff0000, v245
    v_mul_f32 v12, v10, v12
    v_mov_b32 v11, v10
    v_sub_f32 v12, 0, v12
    v_mov_b32 v13, v12
    v_lshlrev_b32 v44, 16, v246
    v_and_b32 v45, 0xffff0000, v246
    v_lshlrev_b32 v46, 16, v247
    v_and_b32 v47, 0xffff0000, v247
    v_pk_fma_f32 v[48:49], v[32:33], v[10:11], v[12:13]
    v_pk_fma_f32 v[50:51], v[34:35], v[10:11], v[12:13]
    v_pk_fma_f32 v[52:53], v[36:37], v[10:11], v[12:13]
    v_pk_fma_f32 v[54:55], v[38:39], v[10:11], v[12:13]
    v_pk_fma_f32 v[56:57], v[40:41], v[10:11], v[12:13]
    v_pk_fma_f32 v[58:59], v[42:43], v[10:11], v[12:13]
    v_pk_fma_f32 v[60:61], v[44:45], v[10:11], v[12:13]
    v_pk_fma_f32 v[62:63], v[46:47], v[10:11], v[12:13]
    v_cvt_pk_bf16_f32 v16, v48, v49
    v_cvt_pk_bf16_f32 v17, v50, v51
    v_cvt_pk_bf16_f32 v18, v52, v53
    v_cvt_pk_bf16_f32 v19, v54, v55
    v_cvt_pk_bf16_f32 v20, v56, v57
    v_cvt_pk_bf16_f32 v21, v58, v59
    v_cvt_pk_bf16_f32 v22, v60, v61
    v_cvt_pk_bf16_f32 v23, v62, v63
    ds_write_b128 v7, v[16:19] offset:0
    ds_write_b128 v7, v[20:23] offset:1024
    s_waitcnt lgkmcnt(0)
    s_barrier
    ds_read_b128 v[32:35], v2 offset:0
    ds_read_b128 v[36:39], v2 offset:1024
    s_waitcnt lgkmcnt(1)
    buffer_store_dwordx4 v[32:35], v4, s[24:27], 0 offen sc1
    s_waitcnt lgkmcnt(0)
    buffer_store_dwordx4 v[36:39], v4, s[24:27], s22 offen sc1
    s_waitcnt vmcnt(0)
    s_barrier
    v_lshrrev_b32 v2, 6, v0
    v_and_b32 v1, 63, v0
    v_readfirstlane_b32 s3, v2
    s_nop 3
    s_cmp_lt_u32 s3, 4
    s_cbranch_scc1 Lg1a_main
    s_cmp_lg_u32 s3, 4
    s_cbranch_scc1 Lg1a_nh
    s_add_u32 s64, s6, 58720256
    s_addc_u32 s65, s7, 0
    s_and_b32 s65, s65, 0xffff
    s_mov_b32 s66, 262144
    s_mov_b32 s67, 0x20000
    s_lshl_b32 s68, s2, 10
    v_mov_b32 v81, 1
    v_mov_b32 v82, 0x200
    v_and_b32 v80, 63, v0
    s_mov_b64 exec, 1
    buffer_store_dword v81, v82, s[64:67], s68 offen sc1
    s_mov_b64 exec, 0xffff
    s_and_b32 s68, s2, 7
    s_lshr_b32 s69, s2, 3
    s_and_b32 s70, s68, 1
    s_lshl_b32 s70, s70, 3
    s_and_b32 s71, s69, 7
    s_add_u32 s70, s70, s71
    s_lshl_b32 s70, s70, 4
    v_add_u32 v83, s70, v80
    v_lshl_add_u32 v83, v83, 10, v82
    s_mov_b32 s58, 0x40000
Lg1a_hp:
    buffer_load_dword v84, v83, s[64:67], 0 offen sc1
    s_sub_u32 s58, s58, 1
    s_cbranch_scc1 Lg1a_hg
    s_waitcnt vmcnt(0)
    v_cmp_gt_u32 vcc, 1, v84
    s_cbranch_vccnz Lg1a_hp
Lg1a_hg:
    s_waitcnt vmcnt(0)
    s_mov_b64 exec, -1
Lg1a_nh:
    s_barrier
    s_lshl_b32 s4, s2, 2
    s_add_u32 s4, s4, s3
    s_sub_u32 s4, s4, 4
    s_cmp_ge_u32 s4, 896
    s_cbranch_scc1 Lw_idle
    s_barrier
    s_barrier
    v_lshrrev_b32 v2, 4, v1
    v_and_b32 v3, 15, v1
    s_sub_u32 s26, s3, 4
    s_lshl_b32 s26, s26, 12
    s_add_u32 s26, s26, 135168
    s_lshr_b32 s5, s4, 3
    s_and_b32 s20, s4, 7
    s_lshl_b32 s21, s5, 16
    s_lshl_b32 s22, s20, 8
    s_add_u32 s21, s21, s22
    v_lshlrev_b32 v4, 13, v2
    v_lshl_add_u32 v4, v3, 4, v4
    s_add_u32 s16, s6, 7340032
    s_addc_u32 s17, s7, 0
    s_and_b32 s17, s17, 0xffff
    s_mov_b32 s18, 7340032
    s_mov_b32 s19, 0x20000
    v_lshrrev_b32 v5, 2, v3
    v_lshlrev_b32 v5, 10, v5
    v_and_b32 v6, 3, v3
    v_lshl_add_u32 v5, v6, 6, v5
    v_lshl_add_u32 v5, v2, 8, v5
    v_bfe_u32 v6, v3, 1, 2
    v_lshl_add_u32 v5, v6, 4, v5
    v_add_u32 v5, s26, v5
    v_bfe_u32 v6, v1, 3, 1
    v_xor_b32 v6, v6, v1
    v_lshlrev_b32 v6, 4, v6
    v_add_u32 v8, s26, v6
    v_xor_b32 v9, 32, v8
    v_xor_b32 v10, 64, v8
    v_xor_b32 v11, 96, v8
    v_lshlrev_b32 v7, 4, v1
    s_mul_i32 s20, s20, 112
    s_add_u32 s20, s20, s5
    s_lshl_b32 s28, s20, 13
    s_add_u32 s29, s28, 1024
    s_add_u32 s30, s28, 2048
    s_add_u32 s31, s28, 3072
    s_add_u32 s32, s28, 4096
    s_add_u32 s33, s28, 5120
    s_add_u32 s34, s28, 6144
    s_add_u32 s35, s28, 7168
    s_mov_b32 s24, 0x05040100
    s_mov_b32 s25, 0x07060302
    s_waitcnt vmcnt(0)
    v_perm_b32 v48, v116, v112, s24
    v_perm_b32 v49, v124, v120, s24
    v_perm_b32 v50, v132, v128, s24
    v_perm_b32 v51, v140, v136, s24
    v_xor_b32 v12, 0, v5
    ds_write_b128 v12, v[48:51] offset:0
    v_perm_b32 v52, v116, v112, s25
    v_perm_b32 v53, v124, v120, s25
    v_perm_b32 v54, v132, v128, s25
    v_perm_b32 v55, v140, v136, s25
    v_xor_b32 v13, 16, v5
    ds_write_b128 v13, v[52:55] offset:0
    v_perm_b32 v56, v117, v113, s24
    v_perm_b32 v57, v125, v121, s24
    v_perm_b32 v58, v133, v129, s24
    v_perm_b32 v59, v141, v137, s24
    v_xor_b32 v12, 32, v5
    ds_write_b128 v12, v[56:59] offset:0
    v_perm_b32 v60, v117, v113, s25
    v_perm_b32 v61, v125, v121, s25
    v_perm_b32 v62, v133, v129, s25
    v_perm_b32 v63, v141, v137, s25
    v_xor_b32 v13, 48, v5
    ds_write_b128 v13, v[60:63] offset:0
    s_waitcnt lgkmcnt(0)
    ds_read_b128 v[16:19], v8 offset:0
    ds_read_b128 v[24:27], v9 offset:1024
    ds_read_b128 v[32:35], v8 offset:2048
    ds_read_b128 v[40:43], v9 offset:3072
    s_barrier
    s_barrier
    s_waitcnt lgkmcnt(3)
    buffer_store_dwordx4 v[16:19], v7, s[16:19], s28 offen sc1
    s_waitcnt lgkmcnt(2)
    buffer_store_dwordx4 v[24:27], v7, s[16:19], s30 offen sc1
    s_waitcnt lgkmcnt(1)
    buffer_store_dwordx4 v[32:35], v7, s[16:19], s32 offen sc1
    s_waitcnt lgkmcnt(0)
    buffer_store_dwordx4 v[40:43], v7, s[16:19], s34 offen sc1
    v_perm_b32 v64, v118, v114, s24
    v_perm_b32 v65, v126, v122, s24
    v_perm_b32 v66, v134, v130, s24
    v_perm_b32 v67, v142, v138, s24
    v_xor_b32 v12, 0, v5
    ds_write_b128 v12, v[64:67] offset:0
    v_perm_b32 v68, v118, v114, s25
    v_perm_b32 v69, v126, v122, s25
    v_perm_b32 v70, v134, v130, s25
    v_perm_b32 v71, v142, v138, s25
    v_xor_b32 v13, 16, v5
    ds_write_b128 v13, v[68:71] offset:0
    v_perm_b32 v72, v119, v115, s24
    v_perm_b32 v73, v127, v123, s24
    v_perm_b32 v74, v135, v131, s24
    v_perm_b32 v75, v143, v139, s24
    v_xor_b32 v12, 32, v5
    ds_write_b128 v12, v[72:75] offset:0
    v_perm_b32 v76, v119, v115, s25
    v_perm_b32 v77, v127, v123, s25
    v_perm_b32 v78, v135, v131, s25
    v_perm_b32 v79, v143, v139, s25
    v_xor_b32 v13, 48, v5
    ds_write_b128 v13, v[76:79] offset:0
    s_waitcnt lgkmcnt(0)
    ds_read_b128 v[20:23], v8 offset:0
    ds_read_b128 v[28:31], v9 offset:1024
    ds_read_b128 v[36:39], v8 offset:2048
    ds_read_b128 v[44:47], v9 offset:3072
    s_barrier
    s_barrier
    s_waitcnt lgkmcnt(3)
    buffer_store_dwordx4 v[20:23], v7, s[16:19], s29 offen sc1
    s_waitcnt lgkmcnt(2)
    buffer_store_dwordx4 v[28:31], v7, s[16:19], s31 offen sc1
    s_waitcnt lgkmcnt(1)
    buffer_store_dwordx4 v[36:39], v7, s[16:19], s33 offen sc1
    s_waitcnt lgkmcnt(0)
    buffer_store_dwordx4 v[44:47], v7, s[16:19], s35 offen sc1
    s_barrier
    s_barrier
    s_barrier
    s_barrier
    s_barrier
    s_waitcnt vmcnt(0)
    s_branch Lw_j
Lw_idle:
    s_barrier
    s_barrier
    s_barrier
    s_barrier
    s_barrier
    s_barrier
    s_barrier
    s_barrier
    s_barrier
    s_barrier
    s_barrier
Lw_j:
    s_barrier
    s_cmp_lg_u32 s3, 4
    s_cbranch_scc1 Lw_n
    s_add_u32 s64, s6, 58720256
    s_addc_u32 s65, s7, 0
    s_and_b32 s65, s65, 0xffff
    s_mov_b32 s66, 262144
    s_mov_b32 s67, 0x20000
    v_and_b32 v80, 63, v0
    v_mov_b32 v86, s72
    v_mov_b32 v87, s73
    v_mov_b32 v82, 0
    s_lshl_b32 s68, s2, 10
    s_mov_b64 exec, 1
    buffer_store_dwordx2 v[86:87], v82, s[64:67], s68 offen offset:704 sc1
    s_mov_b64 exec, -1
    s_barrier
    s_barrier
    s_barrier
    s_and_b32 s69, s2, 1
    s_mul_i32 s69, s69, 112
    s_lshr_b32 s68, s2, 7
    s_add_u32 s69, s69, s68
    s_lshl_b32 s69, s69, 10
    v_lshlrev_b32 v80, 11, v80
    s_mov_b32 exec_hi, 0xffffff
    s_mov_b32 s58, 0x40000
    buffer_load_dwordx2 v[84:85], v80, s[64:67], s69 offen offset:704 sc1
    s_barrier
    s_branch Lw_c
Lw_p:
    buffer_load_dwordx2 v[84:85], v80, s[64:67], s69 offen offset:704 sc1
Lw_c:
    s_sub_u32 s58, s58, 1
    s_cbranch_scc1 Lw_g
    s_waitcnt vmcnt(0)
    v_cmp_ne_u64 vcc, s[72:73], v[84:85]
    s_cbranch_vccnz Lw_p
Lw_g:
    s_waitcnt vmcnt(0)
    s_mov_b64 exec, -1
    s_branch Lw_e
Lw_n:
    s_barrier
    s_barrier
    s_barrier
    s_barrier
Lw_e:
    s_barrier
    s_barrier
    s_branch Lg1a_fin
Lg1a_main:
    s_setprio 3
    s_load_dwordx2 s[4:5], s[0:1], 64
    s_and_b32 s28, s2, 7
    s_lshr_b32 s29, s2, 3
    s_and_b32 s30, s28, 1
    s_lshl_b32 s30, s30, 3
    s_and_b32 s31, s29, 7
    s_add_u32 s30, s30, s31
    s_lshr_b32 s31, s28, 1
    s_lshl_b32 s31, s31, 2
    s_lshr_b32 s29, s29, 3
    s_add_u32 s31, s31, s29
    s_mul_i32 s28, s31, 458752
    s_mul_i32 s29, s30, 262144
    s_add_u32 s29, s29, 23068672
    s_lshr_b32 s32, s3, 1
    s_and_b32 s33, s3, 1
    s_mul_i32 s34, s3, 7168
    s_lshl_b32 s35, s3, 12
    v_lshlrev_b32 v8, 4, v1
    v_add_u32 v2, s34, v8
    v_add_u32 v3, s35, v8
    s_add_u32 s35, s35, 28672
    s_waitcnt lgkmcnt(0)
    s_add_u32 s8, s6, s28
    s_addc_u32 s9, s7, 0
    s_and_b32 s9, s9, 0xffff
    s_mov_b32 s10, 458752
    s_mov_b32 s11, 0x20000
    s_add_u32 s12, s6, s29
    s_addc_u32 s13, s7, 0
    s_and_b32 s13, s13, 0xffff
    s_mov_b32 s14, 262144
    s_mov_b32 s15, 0x20000
    v_lshrrev_b32 v9, 4, v1
    s_mul_i32 s28, s31, 448
    s_add_u32 s16, s4, s28
    s_addc_u32 s17, s5, 0
    s_and_b32 s17, s17, 0xffff
    s_mov_b32 s18, 448
    s_mov_b32 s19, 0x20000
    s_lshl_b32 s29, s32, 8
    v_lshl_add_u32 v10, v9, 3, s29
    s_lshl_b32 s29, s32, 5
    v_lshl_add_u32 v11, v9, 3, s29
    buffer_load_dwordx2 v[172:173], v10, s[16:19], 0 offen offset:0
    buffer_load_dwordx2 v[174:175], v10, s[16:19], 0 offen offset:32
    buffer_load_dwordx2 v[176:177], v10, s[16:19], 0 offen offset:64
    buffer_load_dwordx2 v[178:179], v10, s[16:19], 0 offen offset:96
    buffer_load_dwordx2 v[180:181], v10, s[16:19], 0 offen offset:128
    buffer_load_dwordx2 v[182:183], v10, s[16:19], 0 offen offset:160
    buffer_load_dwordx2 v[184:185], v11, s[16:19], 0 offen offset:192
    s_mov_b32 s36, 0
    s_mov_b32 s37, 0
    s_movk_i32 s38, 0x1000
    s_mov_b32 s39, 0
    s_add_u32 s36, s36, 45056
    s_cmp_eq_u32 s36, 135168
    s_cselect_b32 s36, 0, s36
    s_add_u32 s37, s37, 28672
    s_add_u32 s38, s38, 28672
    s_add_u32 s39, s39, 0x4000
    s_add_u32 s36, s36, 45056
    s_cmp_eq_u32 s36, 135168
    s_cselect_b32 s36, 0, s36
    s_add_u32 s37, s37, 28672
    s_add_u32 s38, s38, 28672
    s_add_u32 s39, s39, 0x4000
    v_readfirstlane_b32 s80, v0
    s_and_b32 s81, s2, 7
    s_lshr_b32 s82, s2, 3
    s_nop 1
    s_lshr_b32 s80, s80, 6
    s_lshr_b32 s81, s81, 1
    s_lshl_b32 s81, s81, 2
    s_lshr_b32 s82, s82, 3
    s_add_u32 s81, s81, s82
    s_mul_i32 s81, s81, 458752
    s_add_u32 s84, s6, s81
    s_addc_u32 s85, s7, 0
    s_and_b32 s85, s85, 0xffff
    s_mov_b32 s86, 458752
    s_mov_b32 s87, 0x20000
    s_mul_i32 s80, s80, 7168
    v_and_b32 v92, 63, v0
    v_lshl_add_u32 v92, v92, 4, s80
    s_add_u32 m0, s80, 0
    s_mov_b32 s82, 0
    buffer_load_dwordx4 v92, s[84:87], s82 offen offset:0 lds
    buffer_load_dwordx4 v92, s[84:87], s82 offen offset:1024 lds
    buffer_load_dwordx4 v92, s[84:87], s82 offen offset:2048 lds
    buffer_load_dwordx4 v92, s[84:87], s82 offen offset:3072 lds
    s_add_u32 m0, s80, 4096
    s_mov_b32 s82, 4096
    buffer_load_dwordx4 v92, s[84:87], s82 offen offset:0 lds
    buffer_load_dwordx4 v92, s[84:87], s82 offen offset:1024 lds
    buffer_load_dwordx4 v92, s[84:87], s82 offen offset:2048 lds
    s_add_u32 m0, s80, 45056
    s_mov_b32 s82, 28672
    buffer_load_dwordx4 v92, s[84:87], s82 offen offset:0 lds
    buffer_load_dwordx4 v92, s[84:87], s82 offen offset:1024 lds
    buffer_load_dwordx4 v92, s[84:87], s82 offen offset:2048 lds
    buffer_load_dwordx4 v92, s[84:87], s82 offen offset:3072 lds
    s_add_u32 m0, s80, 49152
    s_mov_b32 s82, 32768
    buffer_load_dwordx4 v92, s[84:87], s82 offen offset:0 lds
    buffer_load_dwordx4 v92, s[84:87], s82 offen offset:1024 lds
    buffer_load_dwordx4 v92, s[84:87], s82 offen offset:2048 lds
    s_add_u32 m0, s80, 90112
    s_mov_b32 s82, 57344
    buffer_load_dwordx4 v92, s[84:87], s82 offen offset:0 lds
    buffer_load_dwordx4 v92, s[84:87], s82 offen offset:1024 lds
    buffer_load_dwordx4 v92, s[84:87], s82 offen offset:2048 lds
    buffer_load_dwordx4 v92, s[84:87], s82 offen offset:3072 lds
    s_add_u32 m0, s80, 94208
    s_mov_b32 s82, 61440
    buffer_load_dwordx4 v92, s[84:87], s82 offen offset:0 lds
    buffer_load_dwordx4 v92, s[84:87], s82 offen offset:1024 lds
    s_mul_i32 s28, s32, 7168
    v_add_u32 v4, s28, v8
    s_lshl_b32 s28, s33, 12
    s_add_u32 s28, s28, 28672
    v_add_u32 v5, s28, v8
    v_mov_b32 v6, v4
    v_mov_b32 v7, v5
    s_mov_b32 s42, 0
    s_mov_b32 s43, 15
    s_barrier
    s_add_u32 m0, s35, 0
    s_mov_b32 s46, 0
    buffer_load_dwordx4 v3, s[12:15], s46 offen offset:0 lds
    buffer_load_dwordx4 v3, s[12:15], s46 offen offset:1024 lds
    buffer_load_dwordx4 v3, s[12:15], s46 offen offset:2048 lds
    buffer_load_dwordx4 v3, s[12:15], s46 offen offset:3072 lds
    s_add_u32 m0, s35, 45056
    s_mov_b32 s46, 16384
    buffer_load_dwordx4 v3, s[12:15], s46 offen offset:0 lds
    buffer_load_dwordx4 v3, s[12:15], s46 offen offset:1024 lds
    buffer_load_dwordx4 v3, s[12:15], s46 offen offset:2048 lds
    buffer_load_dwordx4 v3, s[12:15], s46 offen offset:3072 lds
    s_add_u32 m0, s36, s34
    s_add_u32 m0, m0, 0x1000
    s_waitcnt vmcnt(28)
    v_lshlrev_b32 v16, 16, v172
    v_and_b32 v17, 0xffff0000, v172
    v_lshlrev_b32 v18, 16, v173
    v_and_b32 v19, 0xffff0000, v173
    v_mov_b32 v20, v16
    v_mov_b32 v21, v17
    v_mov_b32 v22, v18
    v_mov_b32 v23, v19
    v_mov_b32 v24, v16
    v_mov_b32 v25, v17
    v_mov_b32 v26, v18
    v_mov_b32 v27, v19
    v_mov_b32 v28, v16
    v_mov_b32 v29, v17
    v_mov_b32 v30, v18
    v_mov_b32 v31, v19
    v_lshlrev_b32 v32, 16, v174
    v_and_b32 v33, 0xffff0000, v174
    v_lshlrev_b32 v34, 16, v175
    v_and_b32 v35, 0xffff0000, v175
    v_mov_b32 v36, v32
    v_mov_b32 v37, v33
    v_mov_b32 v38, v34
    v_mov_b32 v39, v35
    v_mov_b32 v40, v32
    v_mov_b32 v41, v33
    v_mov_b32 v42, v34
    v_mov_b32 v43, v35
    v_mov_b32 v44, v32
    v_mov_b32 v45, v33
    v_mov_b32 v46, v34
    v_mov_b32 v47, v35
    v_lshlrev_b32 v48, 16, v176
    v_and_b32 v49, 0xffff0000, v176
    v_lshlrev_b32 v50, 16, v177
    v_and_b32 v51, 0xffff0000, v177
    v_mov_b32 v52, v48
    v_mov_b32 v53, v49
    v_mov_b32 v54, v50
    v_mov_b32 v55, v51
    v_mov_b32 v56, v48
    v_mov_b32 v57, v49
    v_mov_b32 v58, v50
    v_mov_b32 v59, v51
    v_mov_b32 v60, v48
    v_mov_b32 v61, v49
    v_mov_b32 v62, v50
    v_mov_b32 v63, v51
    v_lshlrev_b32 v64, 16, v178
    v_and_b32 v65, 0xffff0000, v178
    v_lshlrev_b32 v66, 16, v179
    v_and_b32 v67, 0xffff0000, v179
    v_mov_b32 v68, v64
    v_mov_b32 v69, v65
    v_mov_b32 v70, v66
    v_mov_b32 v71, v67
    v_mov_b32 v72, v64
    v_mov_b32 v73, v65
    v_mov_b32 v74, v66
    v_mov_b32 v75, v67
    v_mov_b32 v76, v64
    v_mov_b32 v77, v65
    v_mov_b32 v78, v66
    v_mov_b32 v79, v67
    v_lshlrev_b32 v80, 16, v180
    v_and_b32 v81, 0xffff0000, v180
    v_lshlrev_b32 v82, 16, v181
    v_and_b32 v83, 0xffff0000, v181
    v_mov_b32 v84, v80
    v_mov_b32 v85, v81
    v_mov_b32 v86, v82
    v_mov_b32 v87, v83
    v_mov_b32 v88, v80
    v_mov_b32 v89, v81
    v_mov_b32 v90, v82
    v_mov_b32 v91, v83
    v_mov_b32 v92, v80
    v_mov_b32 v93, v81
    v_mov_b32 v94, v82
    v_mov_b32 v95, v83
    v_lshlrev_b32 v96, 16, v182
    v_and_b32 v97, 0xffff0000, v182
    v_lshlrev_b32 v98, 16, v183
    v_and_b32 v99, 0xffff0000, v183
    v_mov_b32 v100, v96
    v_mov_b32 v101, v97
    v_mov_b32 v102, v98
    v_mov_b32 v103, v99
    v_mov_b32 v104, v96
    v_mov_b32 v105, v97
    v_mov_b32 v106, v98
    v_mov_b32 v107, v99
    v_mov_b32 v108, v96
    v_mov_b32 v109, v97
    v_mov_b32 v110, v98
    v_mov_b32 v111, v99
    v_lshlrev_b32 v112, 16, v184
    v_and_b32 v113, 0xffff0000, v184
    v_lshlrev_b32 v114, 16, v185
    v_and_b32 v115, 0xffff0000, v185
    v_mov_b32 v116, v112
    v_mov_b32 v117, v113
    v_mov_b32 v118, v114
    v_mov_b32 v119, v115
    v_mov_b32 v120, v112
    v_mov_b32 v121, v113
    v_mov_b32 v122, v114
    v_mov_b32 v123, v115
    v_mov_b32 v124, v112
    v_mov_b32 v125, v113
    v_mov_b32 v126, v114
    v_mov_b32 v127, v115
    s_waitcnt vmcnt(4)
    s_barrier
    ds_read_b128 v[144:147], v6 offset:0
    ds_read_b128 v[128:131], v7 offset:0
    ds_read_b128 v[132:135], v7 offset:1024
    ds_read_b128 v[136:139], v7 offset:2048
    ds_read_b128 v[140:143], v7 offset:3072
    ds_read_b128 v[148:151], v6 offset:1024
    ds_read_b128 v[152:155], v6 offset:2048
    ds_read_b128 v[156:159], v6 offset:3072
    ds_read_b128 v[160:163], v6 offset:4096
    ds_read_b128 v[164:167], v6 offset:5120
    ds_read_b128 v[168:171], v6 offset:6144
    s_waitcnt lgkmcnt(0)
    v_mfma_f32_16x16x32_bf16 v[16:19], v[144:147], v[128:131], v[16:19]
    ds_read_b128 v[188:191], v6 offset:14336
    v_mfma_f32_16x16x32_bf16 v[20:23], v[144:147], v[132:135], v[20:23]
    ds_read_b128 v[172:175], v7 offset:8192
    v_mfma_f32_16x16x32_bf16 v[24:27], v[144:147], v[136:139], v[24:27]
    ds_read_b128 v[176:179], v7 offset:9216
    buffer_load_dwordx4 v2, s[8:11], s38 offen offset:2048 lds
    v_mfma_f32_16x16x32_bf16 v[28:31], v[144:147], v[140:143], v[28:31]
    ds_read_b128 v[180:183], v7 offset:10240
    v_mfma_f32_16x16x32_bf16 v[32:35], v[148:151], v[128:131], v[32:35]
    ds_read_b128 v[184:187], v7 offset:11264
    v_mfma_f32_16x16x32_bf16 v[36:39], v[148:151], v[132:135], v[36:39]
    ds_read_b128 v[192:195], v6 offset:15360
    v_mfma_f32_16x16x32_bf16 v[40:43], v[148:151], v[136:139], v[40:43]
    ds_read_b128 v[196:199], v6 offset:16384
    v_mfma_f32_16x16x32_bf16 v[44:47], v[148:151], v[140:143], v[44:47]
    ds_read_b128 v[200:203], v6 offset:17408
    s_add_u32 m0, s36, s35
    v_mfma_f32_16x16x32_bf16 v[48:51], v[152:155], v[128:131], v[48:51]
    ds_read_b128 v[204:207], v6 offset:18432
    buffer_load_dwordx4 v3, s[12:15], s39 offen offset:0 lds
    v_mfma_f32_16x16x32_bf16 v[52:55], v[152:155], v[132:135], v[52:55]
    ds_read_b128 v[208:211], v6 offset:19456
    v_mfma_f32_16x16x32_bf16 v[56:59], v[152:155], v[136:139], v[56:59]
    ds_read_b128 v[212:215], v6 offset:20480
    v_mfma_f32_16x16x32_bf16 v[60:63], v[152:155], v[140:143], v[60:63]
    v_mfma_f32_16x16x32_bf16 v[64:67], v[156:159], v[128:131], v[64:67]
    v_mfma_f32_16x16x32_bf16 v[68:71], v[156:159], v[132:135], v[68:71]
    v_mfma_f32_16x16x32_bf16 v[72:75], v[156:159], v[136:139], v[72:75]
    buffer_load_dwordx4 v3, s[12:15], s39 offen offset:1024 lds
    v_mfma_f32_16x16x32_bf16 v[76:79], v[156:159], v[140:143], v[76:79]
    v_mfma_f32_16x16x32_bf16 v[80:83], v[160:163], v[128:131], v[80:83]
    v_mfma_f32_16x16x32_bf16 v[84:87], v[160:163], v[132:135], v[84:87]
    v_mfma_f32_16x16x32_bf16 v[88:91], v[160:163], v[136:139], v[88:91]
    v_mfma_f32_16x16x32_bf16 v[92:95], v[160:163], v[140:143], v[92:95]
    buffer_load_dwordx4 v3, s[12:15], s39 offen offset:2048 lds
    v_mfma_f32_16x16x32_bf16 v[96:99], v[164:167], v[128:131], v[96:99]
    v_mfma_f32_16x16x32_bf16 v[100:103], v[164:167], v[132:135], v[100:103]
    v_mfma_f32_16x16x32_bf16 v[104:107], v[164:167], v[136:139], v[104:107]
    v_mfma_f32_16x16x32_bf16 v[108:111], v[164:167], v[140:143], v[108:111]
    v_mfma_f32_16x16x32_bf16 v[112:115], v[168:171], v[128:131], v[112:115]
    v_mfma_f32_16x16x32_bf16 v[116:119], v[168:171], v[132:135], v[116:119]
    buffer_load_dwordx4 v3, s[12:15], s39 offen offset:3072 lds
    v_mfma_f32_16x16x32_bf16 v[120:123], v[168:171], v[136:139], v[120:123]
    v_mfma_f32_16x16x32_bf16 v[124:127], v[168:171], v[140:143], v[124:127]
    s_add_u32 s36, s36, 45056
    s_cmp_eq_u32 s36, 135168
    s_cselect_b32 s36, 0, s36
    s_add_u32 s37, s37, 28672
    s_add_u32 s38, s38, 28672
    s_add_u32 s39, s39, 0x4000
    s_add_u32 s42, s42, 45056
    s_cmp_eq_u32 s42, 135168
    s_cselect_b32 s42, 0, s42
    v_add_u32 v6, s42, v4
    v_add_u32 v7, s42, v5
    s_waitcnt vmcnt(5) lgkmcnt(0)
    s_barrier
    v_mfma_f32_16x16x32_bf16 v[16:19], v[188:191], v[172:175], v[16:19]
    ds_read_b128 v[144:147], v6 offset:0
    v_mfma_f32_16x16x32_bf16 v[20:23], v[188:191], v[176:179], v[20:23]
    ds_read_b128 v[128:131], v7 offset:0
    s_add_u32 m0, s36, s34
    v_mfma_f32_16x16x32_bf16 v[24:27], v[188:191], v[180:183], v[24:27]
    ds_read_b128 v[132:135], v7 offset:1024
    buffer_load_dwordx4 v2, s[8:11], s37 offen offset:0 lds
    v_mfma_f32_16x16x32_bf16 v[28:31], v[188:191], v[184:187], v[28:31]
    ds_read_b128 v[136:139], v7 offset:2048
    v_mfma_f32_16x16x32_bf16 v[32:35], v[192:195], v[172:175], v[32:35]
    ds_read_b128 v[140:143], v7 offset:3072
    v_mfma_f32_16x16x32_bf16 v[36:39], v[192:195], v[176:179], v[36:39]
    ds_read_b128 v[148:151], v6 offset:1024
    v_mfma_f32_16x16x32_bf16 v[40:43], v[192:195], v[180:183], v[40:43]
    ds_read_b128 v[152:155], v6 offset:2048
    v_mfma_f32_16x16x32_bf16 v[44:47], v[192:195], v[184:187], v[44:47]
    ds_read_b128 v[156:159], v6 offset:3072
    buffer_load_dwordx4 v2, s[8:11], s37 offen offset:1024 lds
    v_mfma_f32_16x16x32_bf16 v[48:51], v[196:199], v[172:175], v[48:51]
    ds_read_b128 v[160:163], v6 offset:4096
    v_mfma_f32_16x16x32_bf16 v[52:55], v[196:199], v[176:179], v[52:55]
    ds_read_b128 v[164:167], v6 offset:5120
    v_mfma_f32_16x16x32_bf16 v[56:59], v[196:199], v[180:183], v[56:59]
    ds_read_b128 v[168:171], v6 offset:6144
    v_mfma_f32_16x16x32_bf16 v[60:63], v[196:199], v[184:187], v[60:63]
    buffer_load_dwordx4 v2, s[8:11], s37 offen offset:2048 lds
    v_mfma_f32_16x16x32_bf16 v[64:67], v[200:203], v[172:175], v[64:67]
    v_mfma_f32_16x16x32_bf16 v[68:71], v[200:203], v[176:179], v[68:71]
    v_mfma_f32_16x16x32_bf16 v[72:75], v[200:203], v[180:183], v[72:75]
    v_mfma_f32_16x16x32_bf16 v[76:79], v[200:203], v[184:187], v[76:79]
    v_mfma_f32_16x16x32_bf16 v[80:83], v[204:207], v[172:175], v[80:83]
    buffer_load_dwordx4 v2, s[8:11], s37 offen offset:3072 lds
    v_mfma_f32_16x16x32_bf16 v[84:87], v[204:207], v[176:179], v[84:87]
    v_mfma_f32_16x16x32_bf16 v[88:91], v[204:207], v[180:183], v[88:91]
    v_mfma_f32_16x16x32_bf16 v[92:95], v[204:207], v[184:187], v[92:95]
    v_mfma_f32_16x16x32_bf16 v[96:99], v[208:211], v[172:175], v[96:99]
    s_add_u32 m0, m0, 0x1000
    v_mfma_f32_16x16x32_bf16 v[100:103], v[208:211], v[176:179], v[100:103]
    buffer_load_dwordx4 v2, s[8:11], s38 offen offset:0 lds
    v_mfma_f32_16x16x32_bf16 v[104:107], v[208:211], v[180:183], v[104:107]
    v_mfma_f32_16x16x32_bf16 v[108:111], v[208:211], v[184:187], v[108:111]
    v_mfma_f32_16x16x32_bf16 v[112:115], v[212:215], v[172:175], v[112:115]
    v_mfma_f32_16x16x32_bf16 v[116:119], v[212:215], v[176:179], v[116:119]
    buffer_load_dwordx4 v2, s[8:11], s38 offen offset:1024 lds
    v_mfma_f32_16x16x32_bf16 v[120:123], v[212:215], v[180:183], v[120:123]
    v_mfma_f32_16x16x32_bf16 v[124:127], v[212:215], v[184:187], v[124:127]
.p2align 3
Lg1a_loop:
    s_waitcnt lgkmcnt(0)
    s_nop 0
    v_mfma_f32_16x16x32_bf16 v[16:19], v[144:147], v[128:131], v[16:19]
    ds_read_b128 v[188:191], v6 offset:14336
    v_mfma_f32_16x16x32_bf16 v[20:23], v[144:147], v[132:135], v[20:23]
    ds_read_b128 v[172:175], v7 offset:8192
    v_mfma_f32_16x16x32_bf16 v[24:27], v[144:147], v[136:139], v[24:27]
    ds_read_b128 v[176:179], v7 offset:9216
    buffer_load_dwordx4 v2, s[8:11], s38 offen offset:2048 lds
    v_mfma_f32_16x16x32_bf16 v[28:31], v[144:147], v[140:143], v[28:31]
    ds_read_b128 v[180:183], v7 offset:10240
    v_mfma_f32_16x16x32_bf16 v[32:35], v[148:151], v[128:131], v[32:35]
    ds_read_b128 v[184:187], v7 offset:11264
    v_mfma_f32_16x16x32_bf16 v[36:39], v[148:151], v[132:135], v[36:39]
    ds_read_b128 v[192:195], v6 offset:15360
    v_mfma_f32_16x16x32_bf16 v[40:43], v[148:151], v[136:139], v[40:43]
    ds_read_b128 v[196:199], v6 offset:16384
    v_mfma_f32_16x16x32_bf16 v[44:47], v[148:151], v[140:143], v[44:47]
    ds_read_b128 v[200:203], v6 offset:17408
    s_add_u32 m0, s36, s35
    s_nop 0
    v_mfma_f32_16x16x32_bf16 v[48:51], v[152:155], v[128:131], v[48:51]
    ds_read_b128 v[204:207], v6 offset:18432
    buffer_load_dwordx4 v3, s[12:15], s39 offen offset:0 lds
    v_mfma_f32_16x16x32_bf16 v[52:55], v[152:155], v[132:135], v[52:55]
    ds_read_b128 v[208:211], v6 offset:19456
    v_mfma_f32_16x16x32_bf16 v[56:59], v[152:155], v[136:139], v[56:59]
    ds_read_b128 v[212:215], v6 offset:20480
    v_mfma_f32_16x16x32_bf16 v[60:63], v[152:155], v[140:143], v[60:63]
    v_mfma_f32_16x16x32_bf16 v[64:67], v[156:159], v[128:131], v[64:67]
    v_mfma_f32_16x16x32_bf16 v[68:71], v[156:159], v[132:135], v[68:71]
    v_mfma_f32_16x16x32_bf16 v[72:75], v[156:159], v[136:139], v[72:75]
    buffer_load_dwordx4 v3, s[12:15], s39 offen offset:1024 lds
    v_mfma_f32_16x16x32_bf16 v[76:79], v[156:159], v[140:143], v[76:79]
    v_mfma_f32_16x16x32_bf16 v[80:83], v[160:163], v[128:131], v[80:83]
    v_mfma_f32_16x16x32_bf16 v[84:87], v[160:163], v[132:135], v[84:87]
    v_mfma_f32_16x16x32_bf16 v[88:91], v[160:163], v[136:139], v[88:91]
    v_mfma_f32_16x16x32_bf16 v[92:95], v[160:163], v[140:143], v[92:95]
    buffer_load_dwordx4 v3, s[12:15], s39 offen offset:2048 lds
    v_mfma_f32_16x16x32_bf16 v[96:99], v[164:167], v[128:131], v[96:99]
    v_mfma_f32_16x16x32_bf16 v[100:103], v[164:167], v[132:135], v[100:103]
    v_mfma_f32_16x16x32_bf16 v[104:107], v[164:167], v[136:139], v[104:107]
    v_mfma_f32_16x16x32_bf16 v[108:111], v[164:167], v[140:143], v[108:111]
    v_mfma_f32_16x16x32_bf16 v[112:115], v[168:171], v[128:131], v[112:115]
    v_mfma_f32_16x16x32_bf16 v[116:119], v[168:171], v[132:135], v[116:119]
    buffer_load_dwordx4 v3, s[12:15], s39 offen offset:3072 lds
    v_mfma_f32_16x16x32_bf16 v[120:123], v[168:171], v[136:139], v[120:123]
    v_mfma_f32_16x16x32_bf16 v[124:127], v[168:171], v[140:143], v[124:127]
    s_add_u32 s36, s36, 45056
    s_cmp_eq_u32 s36, 135168
    s_cselect_b32 s36, 0, s36
    s_nop 0
    s_add_u32 s37, s37, 28672
    s_add_u32 s38, s38, 28672
    s_add_u32 s39, s39, 0x4000
    s_add_u32 s42, s42, 45056
    s_cmp_eq_u32 s42, 135168
    s_cselect_b32 s42, 0, s42
    v_add_u32 v6, s42, v4
    v_add_u32 v7, s42, v5
    s_waitcnt vmcnt(11) lgkmcnt(0)
    s_barrier
    s_nop 0
    v_mfma_f32_16x16x32_bf16 v[16:19], v[188:191], v[172:175], v[16:19]
    ds_read_b128 v[144:147], v6 offset:0
    v_mfma_f32_16x16x32_bf16 v[20:23], v[188:191], v[176:179], v[20:23]
    ds_read_b128 v[128:131], v7 offset:0
    s_add_u32 m0, s36, s34
    s_nop 0
    v_mfma_f32_16x16x32_bf16 v[24:27], v[188:191], v[180:183], v[24:27]
    ds_read_b128 v[132:135], v7 offset:1024
    buffer_load_dwordx4 v2, s[8:11], s37 offen offset:0 lds
    v_mfma_f32_16x16x32_bf16 v[28:31], v[188:191], v[184:187], v[28:31]
    ds_read_b128 v[136:139], v7 offset:2048
    v_mfma_f32_16x16x32_bf16 v[32:35], v[192:195], v[172:175], v[32:35]
    ds_read_b128 v[140:143], v7 offset:3072
    v_mfma_f32_16x16x32_bf16 v[36:39], v[192:195], v[176:179], v[36:39]
    ds_read_b128 v[148:151], v6 offset:1024
    v_mfma_f32_16x16x32_bf16 v[40:43], v[192:195], v[180:183], v[40:43]
    ds_read_b128 v[152:155], v6 offset:2048
    v_mfma_f32_16x16x32_bf16 v[44:47], v[192:195], v[184:187], v[44:47]
    ds_read_b128 v[156:159], v6 offset:3072
    buffer_load_dwordx4 v2, s[8:11], s37 offen offset:1024 lds
    v_mfma_f32_16x16x32_bf16 v[48:51], v[196:199], v[172:175], v[48:51]
    ds_read_b128 v[160:163], v6 offset:4096
    v_mfma_f32_16x16x32_bf16 v[52:55], v[196:199], v[176:179], v[52:55]
    ds_read_b128 v[164:167], v6 offset:5120
    v_mfma_f32_16x16x32_bf16 v[56:59], v[196:199], v[180:183], v[56:59]
    ds_read_b128 v[168:171], v6 offset:6144
    v_mfma_f32_16x16x32_bf16 v[60:63], v[196:199], v[184:187], v[60:63]
    buffer_load_dwordx4 v2, s[8:11], s37 offen offset:2048 lds
    v_mfma_f32_16x16x32_bf16 v[64:67], v[200:203], v[172:175], v[64:67]
    v_mfma_f32_16x16x32_bf16 v[68:71], v[200:203], v[176:179], v[68:71]
    v_mfma_f32_16x16x32_bf16 v[72:75], v[200:203], v[180:183], v[72:75]
    v_mfma_f32_16x16x32_bf16 v[76:79], v[200:203], v[184:187], v[76:79]
    v_mfma_f32_16x16x32_bf16 v[80:83], v[204:207], v[172:175], v[80:83]
    buffer_load_dwordx4 v2, s[8:11], s37 offen offset:3072 lds
    v_mfma_f32_16x16x32_bf16 v[84:87], v[204:207], v[176:179], v[84:87]
    v_mfma_f32_16x16x32_bf16 v[88:91], v[204:207], v[180:183], v[88:91]
    v_mfma_f32_16x16x32_bf16 v[92:95], v[204:207], v[184:187], v[92:95]
    v_mfma_f32_16x16x32_bf16 v[96:99], v[208:211], v[172:175], v[96:99]
    s_add_u32 m0, m0, 0x1000
    v_mfma_f32_16x16x32_bf16 v[100:103], v[208:211], v[176:179], v[100:103]
    buffer_load_dwordx4 v2, s[8:11], s38 offen offset:0 lds
    v_mfma_f32_16x16x32_bf16 v[104:107], v[208:211], v[180:183], v[104:107]
    v_mfma_f32_16x16x32_bf16 v[108:111], v[208:211], v[184:187], v[108:111]
    v_mfma_f32_16x16x32_bf16 v[112:115], v[212:215], v[172:175], v[112:115]
    v_mfma_f32_16x16x32_bf16 v[116:119], v[212:215], v[176:179], v[116:119]
    buffer_load_dwordx4 v2, s[8:11], s38 offen offset:1024 lds
    v_mfma_f32_16x16x32_bf16 v[120:123], v[212:215], v[180:183], v[120:123]
    v_mfma_f32_16x16x32_bf16 v[124:127], v[212:215], v[184:187], v[124:127]
    s_sub_u32 s43, s43, 1
    s_cmp_lg_u32 s43, 0
    s_cbranch_scc1 Lg1a_loop
    s_waitcnt vmcnt(0) lgkmcnt(0)
    s_mul_i32 s28, s30, 112
    s_mul_i32 s29, s31, 7
    s_add_u32 s28, s28, s29
    s_lshl_b32 s28, s28, 13
    s_add_u32 s28, s28, 27262976
    s_add_u32 s16, s6, s28
    s_addc_u32 s17, s7, 0
    s_and_b32 s17, s17, 0xffff
    s_mov_b32 s18, 57344
    s_mov_b32 s19, 0x20000
    s_lshl_b32 s28, s32, 15
    s_lshl_b32 s29, s33, 12
    s_add_u32 s28, s28, s29
    v_add_u32 v10, s28, v8
    s_lshl_b32 s28, s32, 3
    s_add_u32 s28, s28, s29
    s_add_u32 s28, s28, 135168
    v_add_u32 v11, s28, v8
    s_lshl_b32 s28, s32, 11
    s_add_u32 s28, s28, s29
    s_add_u32 s29, s28, 135168
    v_add_u32 v12, s29, v8
    s_add_u32 s28, s28, 0x6000
    v_add_u32 v13, s28, v8
    s_movk_i32 s44, 0x2000
    s_movk_i32 s45, 0x4000
    v_max_f32 v112, 0, v112
    v_max_f32 v113, 0, v113
    v_max_f32 v114, 0, v114
    v_max_f32 v115, 0, v115
    v_pk_mul_f32 v[112:113], v[112:113], v[112:113]
    v_pk_mul_f32 v[114:115], v[114:115], v[114:115]
    v_cvt_pk_bf16_f32 v128, v112, v113
    v_cvt_pk_bf16_f32 v129, v114, v115
    ds_write_b64 v11, v[128:129] offset:0
    v_max_f32 v116, 0, v116
    v_max_f32 v117, 0, v117
    v_max_f32 v118, 0, v118
    v_max_f32 v119, 0, v119
    v_pk_mul_f32 v[116:117], v[116:117], v[116:117]
    v_pk_mul_f32 v[118:119], v[118:119], v[118:119]
    v_cvt_pk_bf16_f32 v132, v116, v117
    v_cvt_pk_bf16_f32 v133, v118, v119
    ds_write_b64 v11, v[132:133] offset:1024
    v_max_f32 v120, 0, v120
    v_max_f32 v121, 0, v121
    v_max_f32 v122, 0, v122
    v_max_f32 v123, 0, v123
    v_pk_mul_f32 v[120:121], v[120:121], v[120:121]
    v_pk_mul_f32 v[122:123], v[122:123], v[122:123]
    v_cvt_pk_bf16_f32 v136, v120, v121
    v_cvt_pk_bf16_f32 v137, v122, v123
    ds_write_b64 v11, v[136:137] offset:2048
    v_max_f32 v124, 0, v124
    v_max_f32 v125, 0, v125
    v_max_f32 v126, 0, v126
    v_max_f32 v127, 0, v127
    v_pk_mul_f32 v[124:125], v[124:125], v[124:125]
    v_pk_mul_f32 v[126:127], v[126:127], v[126:127]
    v_cvt_pk_bf16_f32 v140, v124, v125
    v_cvt_pk_bf16_f32 v141, v126, v127
    ds_write_b64 v11, v[140:141] offset:3072
    v_max_f32 v16, 0, v16
    v_max_f32 v17, 0, v17
    v_max_f32 v18, 0, v18
    v_max_f32 v19, 0, v19
    v_pk_mul_f32 v[16:17], v[16:17], v[16:17]
    v_pk_mul_f32 v[18:19], v[18:19], v[18:19]
    v_cvt_pk_bf16_f32 v144, v16, v17
    v_cvt_pk_bf16_f32 v145, v18, v19
    v_max_f32 v32, 0, v32
    v_max_f32 v33, 0, v33
    v_max_f32 v34, 0, v34
    v_max_f32 v35, 0, v35
    v_pk_mul_f32 v[32:33], v[32:33], v[32:33]
    v_pk_mul_f32 v[34:35], v[34:35], v[34:35]
    v_cvt_pk_bf16_f32 v146, v32, v33
    v_cvt_pk_bf16_f32 v147, v34, v35
    buffer_store_dwordx4 v[144:147], v10, s[16:19], 0 offen offset:0 sc1
    v_max_f32 v20, 0, v20
    v_max_f32 v21, 0, v21
    v_max_f32 v22, 0, v22
    v_max_f32 v23, 0, v23
    v_pk_mul_f32 v[20:21], v[20:21], v[20:21]
    v_pk_mul_f32 v[22:23], v[22:23], v[22:23]
    v_cvt_pk_bf16_f32 v148, v20, v21
    v_cvt_pk_bf16_f32 v149, v22, v23
    v_max_f32 v36, 0, v36
    v_max_f32 v37, 0, v37
    v_max_f32 v38, 0, v38
    v_max_f32 v39, 0, v39
    v_pk_mul_f32 v[36:37], v[36:37], v[36:37]
    v_pk_mul_f32 v[38:39], v[38:39], v[38:39]
    v_cvt_pk_bf16_f32 v150, v36, v37
    v_cvt_pk_bf16_f32 v151, v38, v39
    buffer_store_dwordx4 v[148:151], v10, s[16:19], 0 offen offset:1024 sc1
    v_max_f32 v24, 0, v24
    v_max_f32 v25, 0, v25
    v_max_f32 v26, 0, v26
    v_max_f32 v27, 0, v27
    v_pk_mul_f32 v[24:25], v[24:25], v[24:25]
    v_pk_mul_f32 v[26:27], v[26:27], v[26:27]
    v_cvt_pk_bf16_f32 v152, v24, v25
    v_cvt_pk_bf16_f32 v153, v26, v27
    v_max_f32 v40, 0, v40
    v_max_f32 v41, 0, v41
    v_max_f32 v42, 0, v42
    v_max_f32 v43, 0, v43
    v_pk_mul_f32 v[40:41], v[40:41], v[40:41]
    v_pk_mul_f32 v[42:43], v[42:43], v[42:43]
    v_cvt_pk_bf16_f32 v154, v40, v41
    v_cvt_pk_bf16_f32 v155, v42, v43
    buffer_store_dwordx4 v[152:155], v10, s[16:19], 0 offen offset:2048 sc1
    v_max_f32 v28, 0, v28
    v_max_f32 v29, 0, v29
    v_max_f32 v30, 0, v30
    v_max_f32 v31, 0, v31
    v_pk_mul_f32 v[28:29], v[28:29], v[28:29]
    v_pk_mul_f32 v[30:31], v[30:31], v[30:31]
    v_cvt_pk_bf16_f32 v156, v28, v29
    v_cvt_pk_bf16_f32 v157, v30, v31
    v_max_f32 v44, 0, v44
    v_max_f32 v45, 0, v45
    v_max_f32 v46, 0, v46
    v_max_f32 v47, 0, v47
    v_pk_mul_f32 v[44:45], v[44:45], v[44:45]
    v_pk_mul_f32 v[46:47], v[46:47], v[46:47]
    v_cvt_pk_bf16_f32 v158, v44, v45
    v_cvt_pk_bf16_f32 v159, v46, v47
    buffer_store_dwordx4 v[156:159], v10, s[16:19], 0 offen offset:3072 sc1
    s_waitcnt lgkmcnt(0)
    s_barrier
    ds_read_b128 v[128:131], v12 offset:0
    ds_read_b128 v[132:135], v12 offset:1024
    v_max_f32 v48, 0, v48
    v_max_f32 v49, 0, v49
    v_max_f32 v50, 0, v50
    v_max_f32 v51, 0, v51
    v_pk_mul_f32 v[48:49], v[48:49], v[48:49]
    v_pk_mul_f32 v[50:51], v[50:51], v[50:51]
    v_cvt_pk_bf16_f32 v160, v48, v49
    v_cvt_pk_bf16_f32 v161, v50, v51
    v_max_f32 v64, 0, v64
    v_max_f32 v65, 0, v65
    v_max_f32 v66, 0, v66
    v_max_f32 v67, 0, v67
    v_pk_mul_f32 v[64:65], v[64:65], v[64:65]
    v_pk_mul_f32 v[66:67], v[66:67], v[66:67]
    v_cvt_pk_bf16_f32 v162, v64, v65
    v_cvt_pk_bf16_f32 v163, v66, v67
    buffer_store_dwordx4 v[160:163], v10, s[16:19], s44 offen offset:0 sc1
    v_max_f32 v52, 0, v52
    v_max_f32 v53, 0, v53
    v_max_f32 v54, 0, v54
    v_max_f32 v55, 0, v55
    v_pk_mul_f32 v[52:53], v[52:53], v[52:53]
    v_pk_mul_f32 v[54:55], v[54:55], v[54:55]
    v_cvt_pk_bf16_f32 v164, v52, v53
    v_cvt_pk_bf16_f32 v165, v54, v55
    v_max_f32 v68, 0, v68
    v_max_f32 v69, 0, v69
    v_max_f32 v70, 0, v70
    v_max_f32 v71, 0, v71
    v_pk_mul_f32 v[68:69], v[68:69], v[68:69]
    v_pk_mul_f32 v[70:71], v[70:71], v[70:71]
    v_cvt_pk_bf16_f32 v166, v68, v69
    v_cvt_pk_bf16_f32 v167, v70, v71
    buffer_store_dwordx4 v[164:167], v10, s[16:19], s44 offen offset:1024 sc1
    v_max_f32 v56, 0, v56
    v_max_f32 v57, 0, v57
    v_max_f32 v58, 0, v58
    v_max_f32 v59, 0, v59
    v_pk_mul_f32 v[56:57], v[56:57], v[56:57]
    v_pk_mul_f32 v[58:59], v[58:59], v[58:59]
    v_cvt_pk_bf16_f32 v168, v56, v57
    v_cvt_pk_bf16_f32 v169, v58, v59
    v_max_f32 v72, 0, v72
    v_max_f32 v73, 0, v73
    v_max_f32 v74, 0, v74
    v_max_f32 v75, 0, v75
    v_pk_mul_f32 v[72:73], v[72:73], v[72:73]
    v_pk_mul_f32 v[74:75], v[74:75], v[74:75]
    v_cvt_pk_bf16_f32 v170, v72, v73
    v_cvt_pk_bf16_f32 v171, v74, v75
    buffer_store_dwordx4 v[168:171], v10, s[16:19], s44 offen offset:2048 sc1
    v_max_f32 v60, 0, v60
    v_max_f32 v61, 0, v61
    v_max_f32 v62, 0, v62
    v_max_f32 v63, 0, v63
    v_pk_mul_f32 v[60:61], v[60:61], v[60:61]
    v_pk_mul_f32 v[62:63], v[62:63], v[62:63]
    v_cvt_pk_bf16_f32 v172, v60, v61
    v_cvt_pk_bf16_f32 v173, v62, v63
    v_max_f32 v76, 0, v76
    v_max_f32 v77, 0, v77
    v_max_f32 v78, 0, v78
    v_max_f32 v79, 0, v79
    v_pk_mul_f32 v[76:77], v[76:77], v[76:77]
    v_pk_mul_f32 v[78:79], v[78:79], v[78:79]
    v_cvt_pk_bf16_f32 v174, v76, v77
    v_cvt_pk_bf16_f32 v175, v78, v79
    buffer_store_dwordx4 v[172:175], v10, s[16:19], s44 offen offset:3072 sc1
    s_waitcnt lgkmcnt(0)
    buffer_store_dwordx4 v[128:131], v13, s[16:19], 0 offen offset:0 sc1
    buffer_store_dwordx4 v[132:135], v13, s[16:19], 0 offen offset:1024 sc1
    v_max_f32 v80, 0, v80
    v_max_f32 v81, 0, v81
    v_max_f32 v82, 0, v82
    v_max_f32 v83, 0, v83
    v_pk_mul_f32 v[80:81], v[80:81], v[80:81]
    v_pk_mul_f32 v[82:83], v[82:83], v[82:83]
    v_cvt_pk_bf16_f32 v176, v80, v81
    v_cvt_pk_bf16_f32 v177, v82, v83
    v_max_f32 v96, 0, v96
    v_max_f32 v97, 0, v97
    v_max_f32 v98, 0, v98
    v_max_f32 v99, 0, v99
    v_pk_mul_f32 v[96:97], v[96:97], v[96:97]
    v_pk_mul_f32 v[98:99], v[98:99], v[98:99]
    v_cvt_pk_bf16_f32 v178, v96, v97
    v_cvt_pk_bf16_f32 v179, v98, v99
    buffer_store_dwordx4 v[176:179], v10, s[16:19], s45 offen offset:0 sc1
    v_max_f32 v84, 0, v84
    v_max_f32 v85, 0, v85
    v_max_f32 v86, 0, v86
    v_max_f32 v87, 0, v87
    v_pk_mul_f32 v[84:85], v[84:85], v[84:85]
    v_pk_mul_f32 v[86:87], v[86:87], v[86:87]
    v_cvt_pk_bf16_f32 v180, v84, v85
    v_cvt_pk_bf16_f32 v181, v86, v87
    v_max_f32 v100, 0, v100
    v_max_f32 v101, 0, v101
    v_max_f32 v102, 0, v102
    v_max_f32 v103, 0, v103
    v_pk_mul_f32 v[100:101], v[100:101], v[100:101]
    v_pk_mul_f32 v[102:103], v[102:103], v[102:103]
    v_cvt_pk_bf16_f32 v182, v100, v101
    v_cvt_pk_bf16_f32 v183, v102, v103
    buffer_store_dwordx4 v[180:183], v10, s[16:19], s45 offen offset:1024 sc1
    v_max_f32 v88, 0, v88
    v_max_f32 v89, 0, v89
    v_max_f32 v90, 0, v90
    v_max_f32 v91, 0, v91
    v_pk_mul_f32 v[88:89], v[88:89], v[88:89]
    v_pk_mul_f32 v[90:91], v[90:91], v[90:91]
    v_cvt_pk_bf16_f32 v184, v88, v89
    v_cvt_pk_bf16_f32 v185, v90, v91
    v_max_f32 v104, 0, v104
    v_max_f32 v105, 0, v105
    v_max_f32 v106, 0, v106
    v_max_f32 v107, 0, v107
    v_pk_mul_f32 v[104:105], v[104:105], v[104:105]
    v_pk_mul_f32 v[106:107], v[106:107], v[106:107]
    v_cvt_pk_bf16_f32 v186, v104, v105
    v_cvt_pk_bf16_f32 v187, v106, v107
    buffer_store_dwordx4 v[184:187], v10, s[16:19], s45 offen offset:2048 sc1
    v_max_f32 v92, 0, v92
    v_max_f32 v93, 0, v93
    v_max_f32 v94, 0, v94
    v_max_f32 v95, 0, v95
    v_pk_mul_f32 v[92:93], v[92:93], v[92:93]
    v_pk_mul_f32 v[94:95], v[94:95], v[94:95]
    v_cvt_pk_bf16_f32 v188, v92, v93
    v_cvt_pk_bf16_f32 v189, v94, v95
    v_max_f32 v108, 0, v108
    v_max_f32 v109, 0, v109
    v_max_f32 v110, 0, v110
    v_max_f32 v111, 0, v111
    v_pk_mul_f32 v[108:109], v[108:109], v[108:109]
    v_pk_mul_f32 v[110:111], v[110:111], v[110:111]
    v_cvt_pk_bf16_f32 v190, v108, v109
    v_cvt_pk_bf16_f32 v191, v110, v111
    buffer_store_dwordx4 v[188:191], v10, s[16:19], s45 offen offset:3072 sc1
    s_setprio 0
    s_waitcnt vmcnt(0)
Lg1a_fin:
    s_barrier
    v_lshrrev_b32 v2, 6, v0
    v_and_b32 v1, 63, v0
    v_readfirstlane_b32 s3, v2
    s_nop 3
    s_cmp_lt_u32 s3, 4
    s_cbranch_scc1 Lg2a_main
    s_cmp_lg_u32 s3, 4
    s_cbranch_scc1 Lg2a_nh
    s_add_u32 s64, s6, 58720256
    s_addc_u32 s65, s7, 0
    s_and_b32 s65, s65, 0xffff
    s_mov_b32 s66, 262144
    s_mov_b32 s67, 0x20000
    s_lshl_b32 s68, s2, 10
    v_mov_b32 v81, 2
    v_mov_b32 v82, 0x200
    v_and_b32 v80, 63, v0
    s_mov_b64 exec, 1
    buffer_store_dword v81, v82, s[64:67], s68 offen sc1
    s_mov_b64 exec, 0xff
    s_and_b32 s68, s2, 7
    s_lshr_b32 s69, s2, 3
    s_lshr_b32 s70, s68, 1
    s_lshl_b32 s70, s70, 2
    s_and_b32 s71, s69, 3
    s_add_u32 s70, s70, s71
    s_lshr_b32 s71, s70, 3
    s_and_b32 s70, s70, 7
    s_lshl_b32 s70, s70, 3
    s_add_u32 s70, s70, s71
    s_and_b32 s71, s68, 1
    s_lshl_b32 s71, s71, 2
    s_add_u32 s70, s70, s71
    v_lshrrev_b32 v83, 2, v80
    v_lshl_add_u32 v83, v83, 1, s70
    v_and_b32 v84, 3, v80
    v_lshl_add_u32 v83, v84, 6, v83
    v_lshl_add_u32 v83, v83, 10, v82
    s_mov_b32 s58, 0x40000
Lg2a_hp:
    buffer_load_dword v84, v83, s[64:67], 0 offen sc1
    s_sub_u32 s58, s58, 1
    s_cbranch_scc1 Lg2a_hg
    s_waitcnt vmcnt(0)
    v_cmp_gt_u32 vcc, 2, v84
    s_cbranch_vccnz Lg2a_hp
Lg2a_hg:
    s_waitcnt vmcnt(0)
    s_mov_b64 exec, -1
Lg2a_nh:
    s_barrier
    s_movk_i32 s43, 29
Lg2a_hb:
    s_barrier
    s_sub_u32 s43, s43, 1
    s_cmp_lg_u32 s43, 0
    s_cbranch_scc1 Lg2a_hb
    s_waitcnt lgkmcnt(0)
    s_branch Lg2a_fin
Lg2a_main:
    s_setprio 3
    s_load_dwordx2 s[4:5], s[0:1], 80
    s_and_b32 s28, s2, 7
    s_lshr_b32 s29, s2, 3
    s_and_b32 s52, s28, 1
    s_lshr_b32 s30, s28, 1
    s_lshl_b32 s30, s30, 2
    s_and_b32 s31, s29, 3
    s_add_u32 s30, s30, s31
    s_lshr_b32 s31, s29, 2
    s_lshl_b32 s28, s31, 1
    s_add_u32 s28, s28, s52
    s_mul_i32 s28, s28, 458752
    s_add_u32 s28, s28, 7340032
    s_lshl_b32 s29, s30, 1
    s_add_u32 s29, s29, s52
    s_mul_i32 s29, s29, 458752
    s_add_u32 s29, s29, 27262976
    s_lshr_b32 s32, s3, 1
    s_and_b32 s33, s3, 1
    s_mul_i32 s34, s3, 4096
    s_lshl_b32 s35, s3, 12
    v_lshlrev_b32 v8, 4, v1
    v_add_u32 v2, s34, v8
    v_add_u32 v3, s35, v8
    s_add_u32 s35, s35, 16384
    s_waitcnt lgkmcnt(0)
    s_add_u32 s8, s6, s28
    s_addc_u32 s9, s7, 0
    s_and_b32 s9, s9, 0xffff
    s_mov_b32 s10, 458752
    s_mov_b32 s11, 0x20000
    s_add_u32 s12, s6, s29
    s_addc_u32 s13, s7, 0
    s_and_b32 s13, s13, 0xffff
    s_mov_b32 s14, 458752
    s_mov_b32 s15, 0x20000
    v_lshrrev_b32 v9, 4, v1
    s_lshl_b32 s28, s31, 8
    s_add_u32 s16, s4, s28
    s_addc_u32 s17, s5, 0
    s_and_b32 s17, s17, 0xffff
    s_mov_b32 s18, 256
    s_mov_b32 s19, 0x20000
    s_lshl_b32 s29, s30, 18
    s_add_u32 s53, s28, s29
    s_add_u32 s29, s53, 18874368
    s_sub_u32 s47, 0x40000, s28
    s_add_u32 s20, s6, s29
    s_addc_u32 s21, s7, 0
    s_and_b32 s21, s21, 0xffff
    s_mov_b32 s22, s47
    s_mov_b32 s23, 0x20000
    s_lshl_b32 s29, s32, 7
    v_lshl_add_u32 v10, v9, 4, s29
    s_lshl_b32 s29, s33, 17
    s_lshl_b32 s28, s52, 16
    s_add_u32 s29, s29, s28
    s_lshl_b32 s28, s32, 7
    s_add_u32 s29, s29, s28
    v_lshrrev_b32 v11, 3, v1
    v_and_b32 v14, 7, v1
    v_mul_u32_u24 v15, 144, v11
    v_lshl_add_u32 v11, v11, 11, s29
    v_lshl_add_u32 v11, v14, 4, v11
    s_mul_i32 s28, s3, 4608
    s_add_u32 s28, s28, 131072
    v_lshl_add_u32 v15, v14, 4, v15
    v_add_u32 v15, s28, v15
    v_and_b32 v14, 15, v1
    v_mul_u32_u24 v14, 144, v14
    v_lshl_add_u32 v14, v9, 4, v14
    v_add_u32 v14, s28, v14
    s_movk_i32 s44, 0x4000
    s_mov_b32 s45, 0x8000
    s_mov_b32 s60, 0xc000
    buffer_load_dwordx4 v[112:115], v10, s[16:19], 0 offen offset:0
    buffer_load_dwordx4 v[116:119], v10, s[16:19], 0 offen offset:64
    s_mov_b32 s36, 0
    s_mov_b32 s37, 0
    s_movk_i32 s38, 0x1000
    s_mov_b32 s39, 0
    s_add_u32 s36, s36, 32768
    s_cmp_eq_u32 s36, 131072
    s_cselect_b32 s36, 0, s36
    s_add_u32 s37, s37, 16384
    s_add_u32 s39, s39, 0x4000
    s_add_u32 s36, s36, 32768
    s_cmp_eq_u32 s36, 131072
    s_cselect_b32 s36, 0, s36
    s_add_u32 s37, s37, 16384
    s_add_u32 s39, s39, 0x4000
    s_add_u32 s36, s36, 32768
    s_cmp_eq_u32 s36, 131072
    s_cselect_b32 s36, 0, s36
    s_add_u32 s37, s37, 16384
    s_add_u32 s39, s39, 0x4000
    v_readfirstlane_b32 s80, v0
    s_and_b32 s81, s2, 7
    s_lshr_b32 s82, s2, 3
    s_nop 1
    s_lshr_b32 s80, s80, 6
    s_and_b32 s81, s81, 1
    s_lshr_b32 s82, s82, 2
    s_lshl_b32 s82, s82, 1
    s_add_u32 s81, s81, s82
    s_mul_i32 s81, s81, 458752
    s_add_u32 s81, s81, 7340032
    s_add_u32 s84, s6, s81
    s_addc_u32 s85, s7, 0
    s_and_b32 s85, s85, 0xffff
    s_mov_b32 s86, 458752
    s_mov_b32 s87, 0x20000
    s_mul_i32 s80, s80, 4096
    v_and_b32 v92, 63, v0
    v_lshl_add_u32 v92, v92, 4, s80
    s_add_u32 m0, s80, 0
    s_mov_b32 s82, 0
    buffer_load_dwordx4 v92, s[84:87], s82 offen offset:0 lds
    buffer_load_dwordx4 v92, s[84:87], s82 offen offset:1024 lds
    buffer_load_dwordx4 v92, s[84:87], s82 offen offset:2048 lds
    buffer_load_dwordx4 v92, s[84:87], s82 offen offset:3072 lds
    s_add_u32 m0, s80, 32768
    s_mov_b32 s82, 16384
    buffer_load_dwordx4 v92, s[84:87], s82 offen offset:0 lds
    buffer_load_dwordx4 v92, s[84:87], s82 offen offset:1024 lds
    buffer_load_dwordx4 v92, s[84:87], s82 offen offset:2048 lds
    buffer_load_dwordx4 v92, s[84:87], s82 offen offset:3072 lds
    s_add_u32 m0, s80, 65536
    s_mov_b32 s82, 32768
    buffer_load_dwordx4 v92, s[84:87], s82 offen offset:0 lds
    buffer_load_dwordx4 v92, s[84:87], s82 offen offset:1024 lds
    buffer_load_dwordx4 v92, s[84:87], s82 offen offset:2048 lds
    buffer_load_dwordx4 v92, s[84:87], s82 offen offset:3072 lds
    s_add_u32 m0, s80, 98304
    s_mov_b32 s82, 49152
    buffer_load_dwordx4 v92, s[84:87], s82 offen offset:0 lds
    buffer_load_dwordx4 v92, s[84:87], s82 offen offset:1024 lds
    buffer_load_dwordx4 v92, s[84:87], s82 offen offset:2048 lds
    buffer_load_dwordx4 v92, s[84:87], s82 offen offset:3072 lds
    s_mul_i32 s28, s32, 4096
    v_add_u32 v4, s28, v8
    s_lshl_b32 s28, s33, 12
    s_add_u32 s28, s28, 16384
    v_add_u32 v5, s28, v8
    s_lshl_b32 s28, s52, 11
    v_add_u32 v5, s28, v5
    v_xor_b32 v13, 0x800, v5
    v_mov_b32 v12, v13
    v_mov_b32 v6, v4
    v_mov_b32 v7, v5
    s_mov_b32 s42, 0
    s_mov_b32 s43, 26
    s_barrier
    s_add_u32 m0, s35, 0
    s_mov_b32 s46, 0
    buffer_load_dwordx4 v3, s[12:15], s46 offen offset:0 lds
    buffer_load_dwordx4 v3, s[12:15], s46 offen offset:1024 lds
    buffer_load_dwordx4 v3, s[12:15], s46 offen offset:2048 lds
    buffer_load_dwordx4 v3, s[12:15], s46 offen offset:3072 lds
    s_add_u32 m0, s35, 32768
    s_mov_b32 s46, 16384
    buffer_load_dwordx4 v3, s[12:15], s46 offen offset:0 lds
    buffer_load_dwordx4 v3, s[12:15], s46 offen offset:1024 lds
    buffer_load_dwordx4 v3, s[12:15], s46 offen offset:2048 lds
    buffer_load_dwordx4 v3, s[12:15], s46 offen offset:3072 lds
    s_add_u32 m0, s35, 65536
    s_mov_b32 s46, 32768
    buffer_load_dwordx4 v3, s[12:15], s46 offen offset:0 lds
    buffer_load_dwordx4 v3, s[12:15], s46 offen offset:1024 lds
    buffer_load_dwordx4 v3, s[12:15], s46 offen offset:2048 lds
    buffer_load_dwordx4 v3, s[12:15], s46 offen offset:3072 lds
    s_waitcnt vmcnt(28)
    v_lshlrev_b32 v16, 16, v112
    v_mov_b32 v20, v16
    v_mov_b32 v24, 0
    v_mov_b32 v28, 0
    v_and_b32 v17, 0xffff0000, v112
    v_mov_b32 v21, v17
    v_mov_b32 v25, 0
    v_mov_b32 v29, 0
    v_lshlrev_b32 v18, 16, v113
    v_mov_b32 v22, v18
    v_mov_b32 v26, 0
    v_mov_b32 v30, 0
    v_and_b32 v19, 0xffff0000, v113
    v_mov_b32 v23, v19
    v_mov_b32 v27, 0
    v_mov_b32 v31, 0
    v_lshlrev_b32 v32, 16, v114
    v_mov_b32 v36, v32
    v_mov_b32 v40, 0
    v_mov_b32 v44, 0
    v_and_b32 v33, 0xffff0000, v114
    v_mov_b32 v37, v33
    v_mov_b32 v41, 0
    v_mov_b32 v45, 0
    v_lshlrev_b32 v34, 16, v115
    v_mov_b32 v38, v34
    v_mov_b32 v42, 0
    v_mov_b32 v46, 0
    v_and_b32 v35, 0xffff0000, v115
    v_mov_b32 v39, v35
    v_mov_b32 v43, 0
    v_mov_b32 v47, 0
    v_lshlrev_b32 v48, 16, v116
    v_mov_b32 v52, v48
    v_mov_b32 v56, 0
    v_mov_b32 v60, 0
    v_and_b32 v49, 0xffff0000, v116
    v_mov_b32 v53, v49
    v_mov_b32 v57, 0
    v_mov_b32 v61, 0
    v_lshlrev_b32 v50, 16, v117
    v_mov_b32 v54, v50
    v_mov_b32 v58, 0
    v_mov_b32 v62, 0
    v_and_b32 v51, 0xffff0000, v117
    v_mov_b32 v55, v51
    v_mov_b32 v59, 0
    v_mov_b32 v63, 0
    v_lshlrev_b32 v64, 16, v118
    v_mov_b32 v68, v64
    v_mov_b32 v72, 0
    v_mov_b32 v76, 0
    v_and_b32 v65, 0xffff0000, v118
    v_mov_b32 v69, v65
    v_mov_b32 v73, 0
    v_mov_b32 v77, 0
    v_lshlrev_b32 v66, 16, v119
    v_mov_b32 v70, v66
    v_mov_b32 v74, 0
    v_mov_b32 v78, 0
    v_and_b32 v67, 0xffff0000, v119
    v_mov_b32 v71, v67
    v_mov_b32 v75, 0
    v_mov_b32 v79, 0
    s_waitcnt vmcnt(8)
    s_barrier
    ds_read_b128 v[96:99], v6 offset:0
    ds_read_b128 v[80:83], v7 offset:0
    ds_read_b128 v[84:87], v7 offset:1024
    ds_read_b128 v[88:91], v12 offset:0
    ds_read_b128 v[92:95], v12 offset:1024
    ds_read_b128 v[100:103], v6 offset:1024
    ds_read_b128 v[104:107], v6 offset:2048
    ds_read_b128 v[108:111], v6 offset:3072
    s_waitcnt lgkmcnt(0)
    v_mfma_f32_16x16x32_bf16 v[16:19], v[96:99], v[80:83], v[16:19]
    ds_read_b128 v[128:131], v6 offset:8192
    v_mfma_f32_16x16x32_bf16 v[20:23], v[96:99], v[84:87], v[20:23]
    ds_read_b128 v[112:115], v7 offset:8192
    s_add_u32 m0, s36, s35
    v_mfma_f32_16x16x32_bf16 v[24:27], v[96:99], v[88:91], v[24:27]
    ds_read_b128 v[116:119], v7 offset:9216
    buffer_load_dwordx4 v3, s[12:15], s39 offen offset:0 lds
    v_mfma_f32_16x16x32_bf16 v[28:31], v[96:99], v[92:95], v[28:31]
    ds_read_b128 v[120:123], v12 offset:8192
    v_mfma_f32_16x16x32_bf16 v[32:35], v[100:103], v[80:83], v[32:35]
    ds_read_b128 v[124:127], v12 offset:9216
    v_mfma_f32_16x16x32_bf16 v[36:39], v[100:103], v[84:87], v[36:39]
    ds_read_b128 v[132:135], v6 offset:9216
    v_mfma_f32_16x16x32_bf16 v[40:43], v[100:103], v[88:91], v[40:43]
    ds_read_b128 v[136:139], v6 offset:10240
    buffer_load_dwordx4 v3, s[12:15], s39 offen offset:1024 lds
    v_mfma_f32_16x16x32_bf16 v[44:47], v[100:103], v[92:95], v[44:47]
    ds_read_b128 v[140:143], v6 offset:11264
    v_mfma_f32_16x16x32_bf16 v[48:51], v[104:107], v[80:83], v[48:51]
    v_mfma_f32_16x16x32_bf16 v[52:55], v[104:107], v[84:87], v[52:55]
    v_mfma_f32_16x16x32_bf16 v[56:59], v[104:107], v[88:91], v[56:59]
    buffer_load_dwordx4 v3, s[12:15], s39 offen offset:2048 lds
    v_mfma_f32_16x16x32_bf16 v[60:63], v[104:107], v[92:95], v[60:63]
    v_mfma_f32_16x16x32_bf16 v[64:67], v[108:111], v[80:83], v[64:67]
    v_mfma_f32_16x16x32_bf16 v[68:71], v[108:111], v[84:87], v[68:71]
    v_mfma_f32_16x16x32_bf16 v[72:75], v[108:111], v[88:91], v[72:75]
    buffer_load_dwordx4 v3, s[12:15], s39 offen offset:3072 lds
    v_mfma_f32_16x16x32_bf16 v[76:79], v[108:111], v[92:95], v[76:79]
    s_add_u32 s36, s36, 32768
    s_cmp_eq_u32 s36, 131072
    s_cselect_b32 s36, 0, s36
    s_add_u32 s37, s37, 16384
    s_add_u32 s39, s39, 0x4000
    s_add_u32 s42, s42, 32768
    s_cmp_eq_u32 s42, 131072
    s_cselect_b32 s42, 0, s42
    v_add_u32 v6, s42, v4
    v_add_u32 v7, s42, v5
    v_add_u32 v12, s42, v13
    s_waitcnt vmcnt(8) lgkmcnt(0)
    s_barrier
    v_mfma_f32_16x16x32_bf16 v[16:19], v[128:131], v[112:115], v[16:19]
    ds_read_b128 v[96:99], v6 offset:0
    v_mfma_f32_16x16x32_bf16 v[20:23], v[128:131], v[116:119], v[20:23]
    ds_read_b128 v[80:83], v7 offset:0
    s_add_u32 m0, s36, s34
    v_mfma_f32_16x16x32_bf16 v[24:27], v[128:131], v[120:123], v[24:27]
    ds_read_b128 v[84:87], v7 offset:1024
    buffer_load_dwordx4 v2, s[8:11], s37 offen offset:0 lds
    v_mfma_f32_16x16x32_bf16 v[28:31], v[128:131], v[124:127], v[28:31]
    ds_read_b128 v[88:91], v12 offset:0
    v_mfma_f32_16x16x32_bf16 v[32:35], v[132:135], v[112:115], v[32:35]
    ds_read_b128 v[92:95], v12 offset:1024
    v_mfma_f32_16x16x32_bf16 v[36:39], v[132:135], v[116:119], v[36:39]
    ds_read_b128 v[100:103], v6 offset:1024
    v_mfma_f32_16x16x32_bf16 v[40:43], v[132:135], v[120:123], v[40:43]
    ds_read_b128 v[104:107], v6 offset:2048
    buffer_load_dwordx4 v2, s[8:11], s37 offen offset:1024 lds
    v_mfma_f32_16x16x32_bf16 v[44:47], v[132:135], v[124:127], v[44:47]
    ds_read_b128 v[108:111], v6 offset:3072
    v_mfma_f32_16x16x32_bf16 v[48:51], v[136:139], v[112:115], v[48:51]
    v_mfma_f32_16x16x32_bf16 v[52:55], v[136:139], v[116:119], v[52:55]
    v_mfma_f32_16x16x32_bf16 v[56:59], v[136:139], v[120:123], v[56:59]
    buffer_load_dwordx4 v2, s[8:11], s37 offen offset:2048 lds
    v_mfma_f32_16x16x32_bf16 v[60:63], v[136:139], v[124:127], v[60:63]
    v_mfma_f32_16x16x32_bf16 v[64:67], v[140:143], v[112:115], v[64:67]
    v_mfma_f32_16x16x32_bf16 v[68:71], v[140:143], v[116:119], v[68:71]
    v_mfma_f32_16x16x32_bf16 v[72:75], v[140:143], v[120:123], v[72:75]
    buffer_load_dwordx4 v2, s[8:11], s37 offen offset:3072 lds
    v_mfma_f32_16x16x32_bf16 v[76:79], v[140:143], v[124:127], v[76:79]
    s_waitcnt lgkmcnt(0)
    v_mfma_f32_16x16x32_bf16 v[16:19], v[96:99], v[80:83], v[16:19]
    ds_read_b128 v[128:131], v6 offset:8192
    v_mfma_f32_16x16x32_bf16 v[20:23], v[96:99], v[84:87], v[20:23]
    ds_read_b128 v[112:115], v7 offset:8192
    s_add_u32 m0, s36, s35
    v_mfma_f32_16x16x32_bf16 v[24:27], v[96:99], v[88:91], v[24:27]
    ds_read_b128 v[116:119], v7 offset:9216
    buffer_load_dwordx4 v3, s[12:15], s39 offen offset:0 lds
    v_mfma_f32_16x16x32_bf16 v[28:31], v[96:99], v[92:95], v[28:31]
    ds_read_b128 v[120:123], v12 offset:8192
    v_mfma_f32_16x16x32_bf16 v[32:35], v[100:103], v[80:83], v[32:35]
    ds_read_b128 v[124:127], v12 offset:9216
    v_mfma_f32_16x16x32_bf16 v[36:39], v[100:103], v[84:87], v[36:39]
    ds_read_b128 v[132:135], v6 offset:9216
    v_mfma_f32_16x16x32_bf16 v[40:43], v[100:103], v[88:91], v[40:43]
    ds_read_b128 v[136:139], v6 offset:10240
    buffer_load_dwordx4 v3, s[12:15], s39 offen offset:1024 lds
    v_mfma_f32_16x16x32_bf16 v[44:47], v[100:103], v[92:95], v[44:47]
    ds_read_b128 v[140:143], v6 offset:11264
    v_mfma_f32_16x16x32_bf16 v[48:51], v[104:107], v[80:83], v[48:51]
    v_mfma_f32_16x16x32_bf16 v[52:55], v[104:107], v[84:87], v[52:55]
    v_mfma_f32_16x16x32_bf16 v[56:59], v[104:107], v[88:91], v[56:59]
    buffer_load_dwordx4 v3, s[12:15], s39 offen offset:2048 lds
    v_mfma_f32_16x16x32_bf16 v[60:63], v[104:107], v[92:95], v[60:63]
    v_mfma_f32_16x16x32_bf16 v[64:67], v[108:111], v[80:83], v[64:67]
    v_mfma_f32_16x16x32_bf16 v[68:71], v[108:111], v[84:87], v[68:71]
    v_mfma_f32_16x16x32_bf16 v[72:75], v[108:111], v[88:91], v[72:75]
    buffer_load_dwordx4 v3, s[12:15], s39 offen offset:3072 lds
    v_mfma_f32_16x16x32_bf16 v[76:79], v[108:111], v[92:95], v[76:79]
    s_add_u32 s36, s36, 32768
    s_cmp_eq_u32 s36, 131072
    s_cselect_b32 s36, 0, s36
    s_add_u32 s37, s37, 16384
    s_add_u32 s39, s39, 0x4000
    s_add_u32 s42, s42, 32768
    s_cmp_eq_u32 s42, 131072
    s_cselect_b32 s42, 0, s42
    v_add_u32 v6, s42, v4
    v_add_u32 v7, s42, v5
    v_add_u32 v12, s42, v13
    s_waitcnt vmcnt(12) lgkmcnt(0)
    s_barrier
    v_mfma_f32_16x16x32_bf16 v[16:19], v[128:131], v[112:115], v[16:19]
    ds_read_b128 v[96:99], v6 offset:0
    v_mfma_f32_16x16x32_bf16 v[20:23], v[128:131], v[116:119], v[20:23]
    ds_read_b128 v[80:83], v7 offset:0
    s_add_u32 m0, s36, s34
    v_mfma_f32_16x16x32_bf16 v[24:27], v[128:131], v[120:123], v[24:27]
    ds_read_b128 v[84:87], v7 offset:1024
    buffer_load_dwordx4 v2, s[8:11], s37 offen offset:0 lds
    v_mfma_f32_16x16x32_bf16 v[28:31], v[128:131], v[124:127], v[28:31]
    ds_read_b128 v[88:91], v12 offset:0
    v_mfma_f32_16x16x32_bf16 v[32:35], v[132:135], v[112:115], v[32:35]
    ds_read_b128 v[92:95], v12 offset:1024
    v_mfma_f32_16x16x32_bf16 v[36:39], v[132:135], v[116:119], v[36:39]
    ds_read_b128 v[100:103], v6 offset:1024
    v_mfma_f32_16x16x32_bf16 v[40:43], v[132:135], v[120:123], v[40:43]
    ds_read_b128 v[104:107], v6 offset:2048
    buffer_load_dwordx4 v2, s[8:11], s37 offen offset:1024 lds
    v_mfma_f32_16x16x32_bf16 v[44:47], v[132:135], v[124:127], v[44:47]
    ds_read_b128 v[108:111], v6 offset:3072
    v_mfma_f32_16x16x32_bf16 v[48:51], v[136:139], v[112:115], v[48:51]
    v_mfma_f32_16x16x32_bf16 v[52:55], v[136:139], v[116:119], v[52:55]
    v_mfma_f32_16x16x32_bf16 v[56:59], v[136:139], v[120:123], v[56:59]
    buffer_load_dwordx4 v2, s[8:11], s37 offen offset:2048 lds
    v_mfma_f32_16x16x32_bf16 v[60:63], v[136:139], v[124:127], v[60:63]
    v_mfma_f32_16x16x32_bf16 v[64:67], v[140:143], v[112:115], v[64:67]
    v_mfma_f32_16x16x32_bf16 v[68:71], v[140:143], v[116:119], v[68:71]
    v_mfma_f32_16x16x32_bf16 v[72:75], v[140:143], v[120:123], v[72:75]
    buffer_load_dwordx4 v2, s[8:11], s37 offen offset:3072 lds
    v_mfma_f32_16x16x32_bf16 v[76:79], v[140:143], v[124:127], v[76:79]
.p2align 3
Lg2a_loop:
    s_waitcnt lgkmcnt(0)
    s_nop 0
    v_mfma_f32_16x16x32_bf16 v[16:19], v[96:99], v[80:83], v[16:19]
    ds_read_b128 v[128:131], v6 offset:8192
    v_mfma_f32_16x16x32_bf16 v[20:23], v[96:99], v[84:87], v[20:23]
    ds_read_b128 v[112:115], v7 offset:8192
    s_add_u32 m0, s36, s35
    s_nop 0
    v_mfma_f32_16x16x32_bf16 v[24:27], v[96:99], v[88:91], v[24:27]
    ds_read_b128 v[116:119], v7 offset:9216
    buffer_load_dwordx4 v3, s[12:15], s39 offen offset:0 lds
    v_mfma_f32_16x16x32_bf16 v[28:31], v[96:99], v[92:95], v[28:31]
    ds_read_b128 v[120:123], v12 offset:8192
    v_mfma_f32_16x16x32_bf16 v[32:35], v[100:103], v[80:83], v[32:35]
    ds_read_b128 v[124:127], v12 offset:9216
    v_mfma_f32_16x16x32_bf16 v[36:39], v[100:103], v[84:87], v[36:39]
    ds_read_b128 v[132:135], v6 offset:9216
    v_mfma_f32_16x16x32_bf16 v[40:43], v[100:103], v[88:91], v[40:43]
    ds_read_b128 v[136:139], v6 offset:10240
    buffer_load_dwordx4 v3, s[12:15], s39 offen offset:1024 lds
    v_mfma_f32_16x16x32_bf16 v[44:47], v[100:103], v[92:95], v[44:47]
    ds_read_b128 v[140:143], v6 offset:11264
    v_mfma_f32_16x16x32_bf16 v[48:51], v[104:107], v[80:83], v[48:51]
    v_mfma_f32_16x16x32_bf16 v[52:55], v[104:107], v[84:87], v[52:55]
    v_mfma_f32_16x16x32_bf16 v[56:59], v[104:107], v[88:91], v[56:59]
    buffer_load_dwordx4 v3, s[12:15], s39 offen offset:2048 lds
    v_mfma_f32_16x16x32_bf16 v[60:63], v[104:107], v[92:95], v[60:63]
    v_mfma_f32_16x16x32_bf16 v[64:67], v[108:111], v[80:83], v[64:67]
    v_mfma_f32_16x16x32_bf16 v[68:71], v[108:111], v[84:87], v[68:71]
    v_mfma_f32_16x16x32_bf16 v[72:75], v[108:111], v[88:91], v[72:75]
    buffer_load_dwordx4 v3, s[12:15], s39 offen offset:3072 lds
    v_mfma_f32_16x16x32_bf16 v[76:79], v[108:111], v[92:95], v[76:79]
    s_add_u32 s36, s36, 32768
    s_cmp_eq_u32 s36, 131072
    s_cselect_b32 s36, 0, s36
    s_nop 0
    s_add_u32 s37, s37, 16384
    s_add_u32 s39, s39, 0x4000
    s_add_u32 s42, s42, 32768
    s_cmp_eq_u32 s42, 131072
    s_cselect_b32 s42, 0, s42
    v_add_u32 v6, s42, v4
    v_add_u32 v7, s42, v5
    v_add_u32 v12, s42, v13
    s_waitcnt vmcnt(16) lgkmcnt(0)
    s_barrier
    v_mfma_f32_16x16x32_bf16 v[16:19], v[128:131], v[112:115], v[16:19]
    ds_read_b128 v[96:99], v6 offset:0
    v_mfma_f32_16x16x32_bf16 v[20:23], v[128:131], v[116:119], v[20:23]
    ds_read_b128 v[80:83], v7 offset:0
    s_add_u32 m0, s36, s34
    s_nop 0
    v_mfma_f32_16x16x32_bf16 v[24:27], v[128:131], v[120:123], v[24:27]
    ds_read_b128 v[84:87], v7 offset:1024
    buffer_load_dwordx4 v2, s[8:11], s37 offen offset:0 lds
    v_mfma_f32_16x16x32_bf16 v[28:31], v[128:131], v[124:127], v[28:31]
    ds_read_b128 v[88:91], v12 offset:0
    v_mfma_f32_16x16x32_bf16 v[32:35], v[132:135], v[112:115], v[32:35]
    ds_read_b128 v[92:95], v12 offset:1024
    v_mfma_f32_16x16x32_bf16 v[36:39], v[132:135], v[116:119], v[36:39]
    ds_read_b128 v[100:103], v6 offset:1024
    v_mfma_f32_16x16x32_bf16 v[40:43], v[132:135], v[120:123], v[40:43]
    ds_read_b128 v[104:107], v6 offset:2048
    buffer_load_dwordx4 v2, s[8:11], s37 offen offset:1024 lds
    v_mfma_f32_16x16x32_bf16 v[44:47], v[132:135], v[124:127], v[44:47]
    ds_read_b128 v[108:111], v6 offset:3072
    v_mfma_f32_16x16x32_bf16 v[48:51], v[136:139], v[112:115], v[48:51]
    v_mfma_f32_16x16x32_bf16 v[52:55], v[136:139], v[116:119], v[52:55]
    v_mfma_f32_16x16x32_bf16 v[56:59], v[136:139], v[120:123], v[56:59]
    buffer_load_dwordx4 v2, s[8:11], s37 offen offset:2048 lds
    v_mfma_f32_16x16x32_bf16 v[60:63], v[136:139], v[124:127], v[60:63]
    v_mfma_f32_16x16x32_bf16 v[64:67], v[140:143], v[112:115], v[64:67]
    v_mfma_f32_16x16x32_bf16 v[68:71], v[140:143], v[116:119], v[68:71]
    v_mfma_f32_16x16x32_bf16 v[72:75], v[140:143], v[120:123], v[72:75]
    buffer_load_dwordx4 v2, s[8:11], s37 offen offset:3072 lds
    v_mfma_f32_16x16x32_bf16 v[76:79], v[140:143], v[124:127], v[76:79]
    s_sub_u32 s43, s43, 1
    s_cmp_lg_u32 s43, 0
    s_cbranch_scc1 Lg2a_loop
    s_waitcnt vmcnt(0) lgkmcnt(0)
    s_lshl_b32 s28, s52, 23
    s_add_u32 s53, s53, s28
    s_add_u32 s53, s53, 41943040
    s_add_u32 s16, s6, s53
    s_addc_u32 s17, s7, 0
    s_and_b32 s17, s17, 0xffff
    s_mov_b32 s18, s47
    s_mov_b32 s19, 0x20000
    v_xor_b32 v10, 0x10000, v11
    v_cvt_pk_bf16_f32 v80, v16, v17
    v_cvt_pk_bf16_f32 v81, v18, v19
    v_cvt_pk_bf16_f32 v82, v32, v33
    v_cvt_pk_bf16_f32 v83, v34, v35
    ds_write_b128 v14, v[80:83] offset:0
    v_cvt_pk_bf16_f32 v84, v48, v49
    v_cvt_pk_bf16_f32 v85, v50, v51
    v_cvt_pk_bf16_f32 v86, v64, v65
    v_cvt_pk_bf16_f32 v87, v66, v67
    ds_write_b128 v14, v[84:87] offset:64
    v_cvt_pk_bf16_f32 v88, v20, v21
    v_cvt_pk_bf16_f32 v89, v22, v23
    v_cvt_pk_bf16_f32 v90, v36, v37
    v_cvt_pk_bf16_f32 v91, v38, v39
    ds_write_b128 v14, v[88:91] offset:2304
    v_cvt_pk_bf16_f32 v92, v52, v53
    v_cvt_pk_bf16_f32 v93, v54, v55
    v_cvt_pk_bf16_f32 v94, v68, v69
    v_cvt_pk_bf16_f32 v95, v70, v71
    ds_write_b128 v14, v[92:95] offset:2368
    ds_read_b128 v[96:99], v15 offset:0
    ds_read_b128 v[100:103], v15 offset:1152
    ds_read_b128 v[104:107], v15 offset:2304
    ds_read_b128 v[108:111], v15 offset:3456
    s_waitcnt lgkmcnt(3)
    buffer_store_dwordx4 v[96:99], v11, s[16:19], 0 offen sc1
    s_waitcnt lgkmcnt(2)
    buffer_store_dwordx4 v[100:103], v11, s[16:19], s44 offen sc1
    s_waitcnt lgkmcnt(1)
    buffer_store_dwordx4 v[104:107], v11, s[16:19], s45 offen sc1
    s_waitcnt lgkmcnt(0)
    buffer_store_dwordx4 v[108:111], v11, s[16:19], s60 offen sc1
    v_cvt_pk_bf16_f32 v112, v24, v25
    v_cvt_pk_bf16_f32 v113, v26, v27
    v_cvt_pk_bf16_f32 v114, v40, v41
    v_cvt_pk_bf16_f32 v115, v42, v43
    ds_write_b128 v14, v[112:115] offset:0
    v_cvt_pk_bf16_f32 v116, v56, v57
    v_cvt_pk_bf16_f32 v117, v58, v59
    v_cvt_pk_bf16_f32 v118, v72, v73
    v_cvt_pk_bf16_f32 v119, v74, v75
    ds_write_b128 v14, v[116:119] offset:64
    v_cvt_pk_bf16_f32 v120, v28, v29
    v_cvt_pk_bf16_f32 v121, v30, v31
    v_cvt_pk_bf16_f32 v122, v44, v45
    v_cvt_pk_bf16_f32 v123, v46, v47
    ds_write_b128 v14, v[120:123] offset:2304
    v_cvt_pk_bf16_f32 v124, v60, v61
    v_cvt_pk_bf16_f32 v125, v62, v63
    v_cvt_pk_bf16_f32 v126, v76, v77
    v_cvt_pk_bf16_f32 v127, v78, v79
    ds_write_b128 v14, v[124:127] offset:2368
    ds_read_b128 v[128:131], v15 offset:0
    ds_read_b128 v[132:135], v15 offset:1152
    ds_read_b128 v[136:139], v15 offset:2304
    ds_read_b128 v[140:143], v15 offset:3456
    s_waitcnt lgkmcnt(3)
    buffer_store_dwordx4 v[128:131], v10, s[16:19], 0 offen sc1
    s_waitcnt lgkmcnt(2)
    buffer_store_dwordx4 v[132:135], v10, s[16:19], s44 offen sc1
    s_waitcnt lgkmcnt(1)
    buffer_store_dwordx4 v[136:139], v10, s[16:19], s45 offen sc1
    s_waitcnt lgkmcnt(0)
    buffer_store_dwordx4 v[140:143], v10, s[16:19], s60 offen sc1
    s_setprio 0
    s_waitcnt vmcnt(0)
Lg2a_fin:
    s_barrier
    v_readfirstlane_b32 s3, v0
    s_nop 3
    s_cmp_lg_u32 s3, 256
    s_cbranch_scc1 Lr2_nh0
    s_add_u32 s64, s6, 58720256
    s_addc_u32 s65, s7, 0
    s_and_b32 s65, s65, 0xffff
    s_mov_b32 s66, 262144
    s_mov_b32 s67, 0x20000
    s_lshl_b32 s68, s2, 10
    v_mov_b32 v81, 3
    v_mov_b32 v82, 0x200
    v_and_b32 v80, 63, v0
    s_mov_b64 exec, 1
    buffer_store_dword v81, v82, s[64:67], s68 offen sc1
    s_mov_b64 exec, -1
Lr2_nh0:
    v_and_b32 v1, 63, v0
    v_lshrrev_b32 v2, 6, v0
    s_lshl_b32 s3, s2, 14
    v_lshlrev_b32 v3, 11, v2
    v_lshl_add_u32 v3, v1, 4, v3
    v_add_u32 v3, s3, v3
    s_lshr_b32 s28, s2, 1
    s_lshl_b32 s28, s28, 15
    s_and_b32 s29, s2, 1
    s_lshl_b32 s30, s29, 6
    s_add_u32 s28, s28, s30
    s_add_u32 s28, s28, 14680064
    v_lshrrev_b32 v5, 2, v0
    v_and_b32 v6, 3, v0
    v_lshlrev_b32 v4, 7, v5
    v_lshl_add_u32 v4, v6, 4, v4
    s_movk_i32 s22, 0x4000
    s_waitcnt lgkmcnt(0)
    s_add_u32 s12, s6, s28
    s_addc_u32 s13, s7, 0
    s_and_b32 s13, s13, 0xffff
    s_mov_b32 s14, 32704
    s_mov_b32 s15, 0x20000
    s_add_u32 s32, s6, 41943040
    s_addc_u32 s33, s7, 0
    s_and_b32 s33, s33, 0xffff
    s_mov_b32 s34, 12582912
    s_mov_b32 s35, 0x20000
    s_mov_b32 s31, 0x800000
    s_movk_i32 s36, 0x4000
    s_add_u32 s16, s6, 67108864
    s_addc_u32 s17, s7, 0
    s_and_b32 s17, s17, 0xffff
    s_mov_b32 s18, 4194304
    s_mov_b32 s19, 0x20000
    s_lshr_b32 s28, s2, 4
    s_lshl_b32 s28, s28, 18
    s_bfe_u32 s30, s2, 0x30001
    s_lshl_b32 s30, s30, 10
    s_add_u32 s28, s28, s30
    s_lshl_b32 s30, s29, 7
    s_add_u32 s28, s28, s30
    s_add_u32 s28, s28, 71303168
    s_add_u32 s24, s6, s28
    s_addc_u32 s25, s7, 0
    s_and_b32 s25, s25, 0xffff
    s_mov_b32 s26, 262144
    s_mov_b32 s27, 0x20000
    v_mul_u32_u24 v6, 4128, v6
    v_lshl_add_u32 v5, v5, 3, v6
    v_lshrrev_b32 v6, 1, v2
    v_and_b32 v7, 1, v2
    v_lshl_add_u32 v6, v7, 2, v6
    v_mul_u32_u24 v6, 2064, v6
    v_lshl_add_u32 v6, v1, 4, v6
    v_mul_u32_u24 v7, 2112, v2
    v_lshl_add_u32 v7, v1, 4, v7
    v_and_b32 v12, 7, v0
    v_lshrrev_b32 v13, 3, v0
    v_mul_u32_u24 v2, 2112, v12
    v_lshl_add_u32 v2, v13, 4, v2
    v_lshrrev_b32 v4, 2, v13
    v_lshlrev_b32 v4, 13, v4
    v_and_b32 v13, 3, v13
    v_lshl_add_u32 v4, v13, 8, v4
    v_lshl_add_u32 v4, v12, 4, v4
    s_mov_b32 s22, 0x20000
    v_add_u32 v5, 135680, v5
    v_add_u32 v6, 135680, v6
    v_add_u32 v7, 118784, v7
    v_add_u32 v2, 118784, v2
    s_mov_b32 s23, 0x3f803f80
    v_readfirstlane_b32 s3, v0
    s_nop 3
    s_cmp_lg_u32 s3, 256
    s_cbranch_scc1 Lr2_nh1
    s_add_u32 s64, s6, 58720256
    s_addc_u32 s65, s7, 0
    s_and_b32 s65, s65, 0xffff
    s_mov_b32 s66, 262144
    s_mov_b32 s67, 0x20000
    s_lshl_b32 s68, s2, 10
    v_mov_b32 v81, 3
    v_mov_b32 v82, 0x200
    v_and_b32 v80, 63, v0
    s_mov_b64 exec, 0xffff
    s_and_b32 s68, s2, 7
    s_lshr_b32 s69, s2, 3
    s_lshr_b32 s70, s2, 6
    s_lshl_b32 s70, s70, 1
    s_bfe_u32 s71, s2, 0x20004
    s_lshl_b32 s71, s71, 3
    s_add_u32 s70, s70, s71
    v_lshrrev_b32 v83, 1, v80
    v_lshl_add_u32 v83, v83, 5, s70
    v_and_b32 v84, 1, v80
    v_add_u32 v83, v83, v84
    v_lshl_add_u32 v83, v83, 10, v82
    s_mov_b32 s58, 0x40000
Lr2_hp:
    buffer_load_dword v84, v83, s[64:67], 0 offen sc1
    s_sub_u32 s58, s58, 1
    s_cbranch_scc1 Lr2_hg
    s_waitcnt vmcnt(0)
    v_cmp_gt_u32 vcc, 3, v84
    s_cbranch_vccnz Lr2_hp
Lr2_hg:
    s_waitcnt vmcnt(0)
    s_mov_b64 exec, -1
Lr2_nh1:
    s_waitcnt lgkmcnt(0)
    s_barrier
    buffer_load_dwordx4 v[64:67], v3, s[32:35], 0 offen offset:0
    buffer_load_dwordx4 v[68:71], v3, s[32:35], s31 offen offset:0
    buffer_load_dwordx4 v[72:75], v3, s[32:35], 0 offen offset:1024
    buffer_load_dwordx4 v[76:79], v3, s[32:35], s31 offen offset:1024
    v_lshlrev_b32 v32, 16, v240
    v_and_b32 v33, 0xffff0000, v240
    v_lshlrev_b32 v34, 16, v241
    v_and_b32 v35, 0xffff0000, v241
    v_lshlrev_b32 v36, 16, v242
    v_and_b32 v37, 0xffff0000, v242
    v_lshlrev_b32 v38, 16, v243
    v_and_b32 v39, 0xffff0000, v243
    v_lshlrev_b32 v40, 16, v244
    v_and_b32 v41, 0xffff0000, v244
    v_lshlrev_b32 v42, 16, v245
    v_and_b32 v43, 0xffff0000, v245
    v_lshlrev_b32 v44, 16, v246
    v_and_b32 v45, 0xffff0000, v246
    v_lshlrev_b32 v46, 16, v247
    v_and_b32 v47, 0xffff0000, v247
    s_waitcnt vmcnt(2)
    v_lshlrev_b32 v48, 16, v64
    v_and_b32 v49, 0xffff0000, v64
    v_lshlrev_b32 v50, 16, v65
    v_and_b32 v51, 0xffff0000, v65
    v_lshlrev_b32 v52, 16, v66
    v_and_b32 v53, 0xffff0000, v66
    v_lshlrev_b32 v54, 16, v67
    v_and_b32 v55, 0xffff0000, v67
    v_lshlrev_b32 v56, 16, v68
    v_and_b32 v57, 0xffff0000, v68
    v_lshlrev_b32 v58, 16, v69
    v_and_b32 v59, 0xffff0000, v69
    v_lshlrev_b32 v60, 16, v70
    v_and_b32 v61, 0xffff0000, v70
    v_lshlrev_b32 v62, 16, v71
    v_and_b32 v63, 0xffff0000, v71
    v_pk_add_f32 v[48:49], v[48:49], v[56:57]
    v_pk_add_f32 v[50:51], v[50:51], v[58:59]
    v_pk_add_f32 v[52:53], v[52:53], v[60:61]
    v_pk_add_f32 v[54:55], v[54:55], v[62:63]
    v_pk_add_f32 v[48:49], v[48:49], v[32:33]
    v_pk_add_f32 v[50:51], v[50:51], v[34:35]
    v_pk_add_f32 v[52:53], v[52:53], v[36:37]
    v_pk_add_f32 v[54:55], v[54:55], v[38:39]
    v_cvt_pk_bf16_f32 v16, v48, v49
    v_cvt_pk_bf16_f32 v17, v50, v51
    v_cvt_pk_bf16_f32 v18, v52, v53
    v_cvt_pk_bf16_f32 v19, v54, v55
    s_waitcnt vmcnt(0)
    v_lshlrev_b32 v48, 16, v72
    v_and_b32 v49, 0xffff0000, v72
    v_lshlrev_b32 v50, 16, v73
    v_and_b32 v51, 0xffff0000, v73
    v_lshlrev_b32 v52, 16, v74
    v_and_b32 v53, 0xffff0000, v74
    v_lshlrev_b32 v54, 16, v75
    v_and_b32 v55, 0xffff0000, v75
    v_lshlrev_b32 v56, 16, v76
    v_and_b32 v57, 0xffff0000, v76
    v_lshlrev_b32 v58, 16, v77
    v_and_b32 v59, 0xffff0000, v77
    v_lshlrev_b32 v60, 16, v78
    v_and_b32 v61, 0xffff0000, v78
    v_lshlrev_b32 v62, 16, v79
    v_and_b32 v63, 0xffff0000, v79
    v_pk_add_f32 v[48:49], v[48:49], v[56:57]
    v_pk_add_f32 v[50:51], v[50:51], v[58:59]
    v_pk_add_f32 v[52:53], v[52:53], v[60:61]
    v_pk_add_f32 v[54:55], v[54:55], v[62:63]
    v_pk_add_f32 v[48:49], v[48:49], v[40:41]
    v_pk_add_f32 v[50:51], v[50:51], v[42:43]
    v_pk_add_f32 v[52:53], v[52:53], v[44:45]
    v_pk_add_f32 v[54:55], v[54:55], v[46:47]
    v_cvt_pk_bf16_f32 v20, v48, v49
    v_cvt_pk_bf16_f32 v21, v50, v51
    v_cvt_pk_bf16_f32 v22, v52, v53
    v_cvt_pk_bf16_f32 v23, v54, v55
    v_dot2_f32_bf16 v8, v16, s23, 0
    v_dot2_f32_bf16 v9, v16, v16, 0
    v_dot2_f32_bf16 v8, v17, s23, v8
    v_dot2_f32_bf16 v9, v17, v17, v9
    v_dot2_f32_bf16 v8, v18, s23, v8
    v_dot2_f32_bf16 v9, v18, v18, v9
    v_dot2_f32_bf16 v8, v19, s23, v8
    v_dot2_f32_bf16 v9, v19, v19, v9
    v_dot2_f32_bf16 v8, v20, s23, v8
    v_dot2_f32_bf16 v9, v20, v20, v9
    v_dot2_f32_bf16 v8, v21, s23, v8
    v_dot2_f32_bf16 v9, v21, v21, v9
    v_dot2_f32_bf16 v8, v22, s23, v8
    v_dot2_f32_bf16 v9, v22, v22, v9
    v_dot2_f32_bf16 v8, v23, s23, v8
    v_dot2_f32_bf16 v9, v23, v23, v9
    v_lshlrev_b32 v32, 16, v16
    v_and_b32 v33, 0xffff0000, v16
    v_lshlrev_b32 v34, 16, v17
    v_add_f32_dpp v8, v8, v8 row_shr:1 row_mask:0xf bank_mask:0xf bound_ctrl:0
    v_add_f32_dpp v9, v9, v9 row_shr:1 row_mask:0xf bank_mask:0xf bound_ctrl:0
    v_and_b32 v35, 0xffff0000, v17
    v_add_f32_dpp v8, v8, v8 row_shr:2 row_mask:0xf bank_mask:0xf bound_ctrl:0
    v_add_f32_dpp v9, v9, v9 row_shr:2 row_mask:0xf bank_mask:0xf bound_ctrl:0
    v_lshlrev_b32 v36, 16, v18
    v_add_f32_dpp v8, v8, v8 row_shr:4 row_mask:0xf bank_mask:0xf bound_ctrl:0
    v_add_f32_dpp v9, v9, v9 row_shr:4 row_mask:0xf bank_mask:0xf bound_ctrl:0
    v_and_b32 v37, 0xffff0000, v18
    v_add_f32_dpp v8, v8, v8 row_shr:8 row_mask:0xf bank_mask:0xf bound_ctrl:0
    v_add_f32_dpp v9, v9, v9 row_shr:8 row_mask:0xf bank_mask:0xf bound_ctrl:0
    v_lshlrev_b32 v38, 16, v19
    v_add_f32_dpp v8, v8, v8 row_bcast:15 row_mask:0xa bank_mask:0xf
    v_add_f32_dpp v9, v9, v9 row_bcast:15 row_mask:0xa bank_mask:0xf
    v_and_b32 v39, 0xffff0000, v19
    v_add_f32_dpp v8, v8, v8 row_bcast:31 row_mask:0xc bank_mask:0xf
    v_add_f32_dpp v9, v9, v9 row_bcast:31 row_mask:0xc bank_mask:0xf
    v_lshlrev_b32 v40, 16, v20
    v_readlane_b32 s20, v8, 63
    v_readlane_b32 s21, v9, 63
    v_mov_b32 v10, 0x3a800000
    v_and_b32 v41, 0xffff0000, v20
    v_mul_f32 v12, s20, v10
    v_mul_f32 v10, s21, v10
    v_fma_f32 v10, -v12, v12, v10
    v_max_f32 v10, 0, v10
    v_cvt_pk_bf16_f32 v10, v10, v10
    v_lshlrev_b32 v10, 16, v10
    v_cvt_pk_bf16_f32 v12, v12, v12
    v_lshlrev_b32 v12, 16, v12
    v_add_f32 v10, 0x3727c5ac, v10
    v_cvt_pk_bf16_f32 v10, v10, v10
    v_lshlrev_b32 v10, 16, v10
    v_sqrt_f32 v10, v10
    v_lshlrev_b32 v42, 16, v21
    v_cvt_pk_bf16_f32 v10, v10, v10
    v_lshlrev_b32 v10, 16, v10
    v_rcp_f32 v10, v10
    v_and_b32 v43, 0xffff0000, v21
    v_mul_f32 v12, v10, v12
    v_mov_b32 v11, v10
    v_sub_f32 v12, 0, v12
    v_mov_b32 v13, v12
    v_lshlrev_b32 v44, 16, v22
    v_and_b32 v45, 0xffff0000, v22
    v_lshlrev_b32 v46, 16, v23
    v_and_b32 v47, 0xffff0000, v23
    s_waitcnt lgkmcnt(0)
    v_lshlrev_b32 v16, 16, v232
    v_and_b32 v17, 0xffff0000, v232
    v_pk_fma_f32 v[48:49], v[32:33], v[10:11], v[12:13]
    v_pk_fma_f32 v[32:33], v[48:49], v[16:17], v[32:33]
    v_lshlrev_b32 v18, 16, v233
    v_and_b32 v19, 0xffff0000, v233
    v_pk_fma_f32 v[50:51], v[34:35], v[10:11], v[12:13]
    v_pk_fma_f32 v[34:35], v[50:51], v[18:19], v[34:35]
    v_lshlrev_b32 v20, 16, v234
    v_and_b32 v21, 0xffff0000, v234
    v_pk_fma_f32 v[52:53], v[36:37], v[10:11], v[12:13]
    v_pk_fma_f32 v[36:37], v[52:53], v[20:21], v[36:37]
    v_lshlrev_b32 v22, 16, v235
    v_and_b32 v23, 0xffff0000, v235
    v_pk_fma_f32 v[54:55], v[38:39], v[10:11], v[12:13]
    v_pk_fma_f32 v[38:39], v[54:55], v[22:23], v[38:39]
    v_lshlrev_b32 v16, 16, v236
    v_and_b32 v17, 0xffff0000, v236
    v_pk_fma_f32 v[56:57], v[40:41], v[10:11], v[12:13]
    v_pk_fma_f32 v[40:41], v[56:57], v[16:17], v[40:41]
    v_lshlrev_b32 v18, 16, v237
    v_and_b32 v19, 0xffff0000, v237
    v_pk_fma_f32 v[58:59], v[42:43], v[10:11], v[12:13]
    v_pk_fma_f32 v[42:43], v[58:59], v[18:19], v[42:43]
    v_lshlrev_b32 v20, 16, v238
    v_and_b32 v21, 0xffff0000, v238
    v_pk_fma_f32 v[60:61], v[44:45], v[10:11], v[12:13]
    v_pk_fma_f32 v[44:45], v[60:61], v[20:21], v[44:45]
    v_lshlrev_b32 v22, 16, v239
    v_and_b32 v23, 0xffff0000, v239
    v_pk_fma_f32 v[62:63], v[46:47], v[10:11], v[12:13]
    v_pk_fma_f32 v[46:47], v[62:63], v[22:23], v[46:47]
    v_cvt_pk_bf16_f32 v240, v32, v33
    v_cvt_pk_bf16_f32 v241, v34, v35
    v_cvt_pk_bf16_f32 v242, v36, v37
    v_cvt_pk_bf16_f32 v243, v38, v39
    v_cvt_pk_bf16_f32 v244, v40, v41
    v_cvt_pk_bf16_f32 v245, v42, v43
    v_cvt_pk_bf16_f32 v246, v44, v45
    v_cvt_pk_bf16_f32 v247, v46, v47
    buffer_store_dwordx4 v[240:243], v3, s[16:19], 0 offen sc1
    buffer_store_dwordx4 v[244:247], v3, s[16:19], 0 offen offset:1024 sc1
    v_dot2_f32_bf16 v8, v240, s23, 0
    v_dot2_f32_bf16 v9, v240, v240, 0
    v_dot2_f32_bf16 v8, v241, s23, v8
    v_dot2_f32_bf16 v9, v241, v241, v9
    v_dot2_f32_bf16 v8, v242, s23, v8
    v_dot2_f32_bf16 v9, v242, v242, v9
    v_dot2_f32_bf16 v8, v243, s23, v8
    v_dot2_f32_bf16 v9, v243, v243, v9
    v_dot2_f32_bf16 v8, v244, s23, v8
    v_dot2_f32_bf16 v9, v244, v244, v9
    v_dot2_f32_bf16 v8, v245, s23, v8
    v_dot2_f32_bf16 v9, v245, v245, v9
    v_dot2_f32_bf16 v8, v246, s23, v8
    v_dot2_f32_bf16 v9, v246, v246, v9
    v_dot2_f32_bf16 v8, v247, s23, v8
    v_dot2_f32_bf16 v9, v247, v247, v9
    v_lshlrev_b32 v32, 16, v240
    v_and_b32 v33, 0xffff0000, v240
    v_lshlrev_b32 v34, 16, v241
    v_add_f32_dpp v8, v8, v8 row_shr:1 row_mask:0xf bank_mask:0xf bound_ctrl:0
    v_add_f32_dpp v9, v9, v9 row_shr:1 row_mask:0xf bank_mask:0xf bound_ctrl:0
    v_and_b32 v35, 0xffff0000, v241
    v_add_f32_dpp v8, v8, v8 row_shr:2 row_mask:0xf bank_mask:0xf bound_ctrl:0
    v_add_f32_dpp v9, v9, v9 row_shr:2 row_mask:0xf bank_mask:0xf bound_ctrl:0
    v_lshlrev_b32 v36, 16, v242
    v_add_f32_dpp v8, v8, v8 row_shr:4 row_mask:0xf bank_mask:0xf bound_ctrl:0
    v_add_f32_dpp v9, v9, v9 row_shr:4 row_mask:0xf bank_mask:0xf bound_ctrl:0
    v_and_b32 v37, 0xffff0000, v242
    v_add_f32_dpp v8, v8, v8 row_shr:8 row_mask:0xf bank_mask:0xf bound_ctrl:0
    v_add_f32_dpp v9, v9, v9 row_shr:8 row_mask:0xf bank_mask:0xf bound_ctrl:0
    v_lshlrev_b32 v38, 16, v243
    v_add_f32_dpp v8, v8, v8 row_bcast:15 row_mask:0xa bank_mask:0xf
    v_add_f32_dpp v9, v9, v9 row_bcast:15 row_mask:0xa bank_mask:0xf
    v_and_b32 v39, 0xffff0000, v243
    v_add_f32_dpp v8, v8, v8 row_bcast:31 row_mask:0xc bank_mask:0xf
    v_add_f32_dpp v9, v9, v9 row_bcast:31 row_mask:0xc bank_mask:0xf
    v_lshlrev_b32 v40, 16, v244
    v_readlane_b32 s20, v8, 63
    v_readlane_b32 s21, v9, 63
    v_mov_b32 v10, 0x3a800000
    v_and_b32 v41, 0xffff0000, v244
    v_mul_f32 v12, s20, v10
    v_mul_f32 v10, s21, v10
    v_fma_f32 v10, -v12, v12, v10
    v_max_f32 v10, 0, v10
    v_cvt_pk_bf16_f32 v10, v10, v10
    v_lshlrev_b32 v10, 16, v10
    v_cvt_pk_bf16_f32 v12, v12, v12
    v_lshlrev_b32 v12, 16, v12
    v_add_f32 v10, 0x3727c5ac, v10
    v_cvt_pk_bf16_f32 v10, v10, v10
    v_lshlrev_b32 v10, 16, v10
    v_sqrt_f32 v10, v10
    v_lshlrev_b32 v42, 16, v245
    v_cvt_pk_bf16_f32 v10, v10, v10
    v_lshlrev_b32 v10, 16, v10
    v_rcp_f32 v10, v10
    v_and_b32 v43, 0xffff0000, v245
    v_mul_f32 v12, v10, v12
    v_mov_b32 v11, v10
    v_sub_f32 v12, 0, v12
    v_mov_b32 v13, v12
    v_lshlrev_b32 v44, 16, v246
    v_and_b32 v45, 0xffff0000, v246
    v_lshlrev_b32 v46, 16, v247
    v_and_b32 v47, 0xffff0000, v247
    v_pk_fma_f32 v[48:49], v[32:33], v[10:11], v[12:13]
    v_pk_fma_f32 v[50:51], v[34:35], v[10:11], v[12:13]
    v_pk_fma_f32 v[52:53], v[36:37], v[10:11], v[12:13]
    v_pk_fma_f32 v[54:55], v[38:39], v[10:11], v[12:13]
    v_pk_fma_f32 v[56:57], v[40:41], v[10:11], v[12:13]
    v_pk_fma_f32 v[58:59], v[42:43], v[10:11], v[12:13]
    v_pk_fma_f32 v[60:61], v[44:45], v[10:11], v[12:13]
    v_pk_fma_f32 v[62:63], v[46:47], v[10:11], v[12:13]
    v_cvt_pk_bf16_f32 v16, v48, v49
    v_cvt_pk_bf16_f32 v17, v50, v51
    v_cvt_pk_bf16_f32 v18, v52, v53
    v_cvt_pk_bf16_f32 v19, v54, v55
    v_cvt_pk_bf16_f32 v20, v56, v57
    v_cvt_pk_bf16_f32 v21, v58, v59
    v_cvt_pk_bf16_f32 v22, v60, v61
    v_cvt_pk_bf16_f32 v23, v62, v63
    ds_write_b128 v7, v[16:19] offset:0
    ds_write_b128 v7, v[20:23] offset:1024
    s_waitcnt lgkmcnt(0)
    s_barrier
    ds_read_b128 v[32:35], v2 offset:0
    ds_read_b128 v[36:39], v2 offset:1024
    s_waitcnt lgkmcnt(1)
    buffer_store_dwordx4 v[32:35], v4, s[24:27], 0 offen sc1
    s_waitcnt lgkmcnt(0)
    buffer_store_dwordx4 v[36:39], v4, s[24:27], s22 offen sc1
    s_waitcnt vmcnt(0)
    s_barrier
    v_lshrrev_b32 v2, 6, v0
    v_and_b32 v1, 63, v0
    v_readfirstlane_b32 s3, v2
    s_nop 3
    s_cmp_lt_u32 s3, 4
    s_cbranch_scc1 Lg1b_main
    s_cmp_lg_u32 s3, 4
    s_cbranch_scc1 Lg1b_nh
    s_add_u32 s64, s6, 58720256
    s_addc_u32 s65, s7, 0
    s_and_b32 s65, s65, 0xffff
    s_mov_b32 s66, 262144
    s_mov_b32 s67, 0x20000
    s_lshl_b32 s68, s2, 10
    v_mov_b32 v81, 4
    v_mov_b32 v82, 0x200
    v_and_b32 v80, 63, v0
    s_mov_b64 exec, 1
    buffer_store_dword v81, v82, s[64:67], s68 offen sc1
    s_mov_b64 exec, 0xffff
    s_and_b32 s68, s2, 7
    s_lshr_b32 s69, s2, 3
    s_and_b32 s70, s68, 1
    s_lshl_b32 s70, s70, 3
    s_and_b32 s71, s69, 7
    s_add_u32 s70, s70, s71
    s_lshl_b32 s70, s70, 4
    v_add_u32 v83, s70, v80
    v_lshl_add_u32 v83, v83, 10, v82
    s_mov_b32 s58, 0x40000
Lg1b_hp:
    buffer_load_dword v84, v83, s[64:67], 0 offen sc1
    s_sub_u32 s58, s58, 1
    s_cbranch_scc1 Lg1b_hg
    s_waitcnt vmcnt(0)
    v_cmp_gt_u32 vcc, 4, v84
    s_cbranch_vccnz Lg1b_hp
Lg1b_hg:
    s_waitcnt vmcnt(0)
    s_mov_b64 exec, -1
Lg1b_nh:
    s_barrier
    s_movk_i32 s43, 18
Lg1b_hb:
    s_barrier
    s_sub_u32 s43, s43, 1
    s_cmp_lg_u32 s43, 0
    s_cbranch_scc1 Lg1b_hb
    s_waitcnt lgkmcnt(0)
    s_branch Lg1b_fin
Lg1b_main:
    s_setprio 3
    s_load_dwordx2 s[4:5], s[0:1], 64
    s_and_b32 s28, s2, 7
    s_lshr_b32 s29, s2, 3
    s_and_b32 s30, s28, 1
    s_lshl_b32 s30, s30, 3
    s_and_b32 s31, s29, 7
    s_add_u32 s30, s30, s31
    s_lshr_b32 s31, s28, 1
    s_lshl_b32 s31, s31, 2
    s_lshr_b32 s29, s29, 3
    s_add_u32 s31, s31, s29
    s_mul_i32 s28, s31, 458752
    s_mul_i32 s29, s30, 262144
    s_add_u32 s29, s29, 71303168
    s_lshr_b32 s32, s3, 1
    s_and_b32 s33, s3, 1
    s_mul_i32 s34, s3, 7168
    s_lshl_b32 s35, s3, 12
    v_lshlrev_b32 v8, 4, v1
    v_add_u32 v2, s34, v8
    v_add_u32 v3, s35, v8
    s_add_u32 s35, s35, 28672
    s_waitcnt lgkmcnt(0)
    s_add_u32 s8, s6, s28
    s_addc_u32 s9, s7, 0
    s_and_b32 s9, s9, 0xffff
    s_mov_b32 s10, 458752
    s_mov_b32 s11, 0x20000
    s_add_u32 s12, s6, s29
    s_addc_u32 s13, s7, 0
    s_and_b32 s13, s13, 0xffff
    s_mov_b32 s14, 262144
    s_mov_b32 s15, 0x20000
    v_lshrrev_b32 v9, 4, v1
    s_mul_i32 s28, s31, 448
    s_add_u32 s16, s4, s28
    s_addc_u32 s17, s5, 0
    s_and_b32 s17, s17, 0xffff
    s_mov_b32 s18, 448
    s_mov_b32 s19, 0x20000
    s_lshl_b32 s29, s32, 8
    v_lshl_add_u32 v10, v9, 3, s29
    s_lshl_b32 s29, s32, 5
    v_lshl_add_u32 v11, v9, 3, s29
    buffer_load_dwordx2 v[172:173], v10, s[16:19], 0 offen offset:0
    buffer_load_dwordx2 v[174:175], v10, s[16:19], 0 offen offset:32
    buffer_load_dwordx2 v[176:177], v10, s[16:19], 0 offen offset:64
    buffer_load_dwordx2 v[178:179], v10, s[16:19], 0 offen offset:96
    buffer_load_dwordx2 v[180:181], v10, s[16:19], 0 offen offset:128
    buffer_load_dwordx2 v[182:183], v10, s[16:19], 0 offen offset:160
    buffer_load_dwordx2 v[184:185], v11, s[16:19], 0 offen offset:192
    s_mov_b32 s36, 0
    s_mov_b32 s37, 0
    s_movk_i32 s38, 0x1000
    s_mov_b32 s39, 0
    s_add_u32 s36, s36, 45056
    s_cmp_eq_u32 s36, 135168
    s_cselect_b32 s36, 0, s36
    s_add_u32 s37, s37, 28672
    s_add_u32 s38, s38, 28672
    s_add_u32 s39, s39, 0x4000
    s_add_u32 s36, s36, 45056
    s_cmp_eq_u32 s36, 135168
    s_cselect_b32 s36, 0, s36
    s_add_u32 s37, s37, 28672
    s_add_u32 s38, s38, 28672
    s_add_u32 s39, s39, 0x4000
    v_readfirstlane_b32 s80, v0
    s_and_b32 s81, s2, 7
    s_lshr_b32 s82, s2, 3
    s_nop 1
    s_lshr_b32 s80, s80, 6
    s_lshr_b32 s81, s81, 1
    s_lshl_b32 s81, s81, 2
    s_lshr_b32 s82, s82, 3
    s_add_u32 s81, s81, s82
    s_mul_i32 s81, s81, 458752
    s_add_u32 s84, s6, s81
    s_addc_u32 s85, s7, 0
    s_and_b32 s85, s85, 0xffff
    s_mov_b32 s86, 458752
    s_mov_b32 s87, 0x20000
    s_mul_i32 s80, s80, 7168
    v_and_b32 v92, 63, v0
    v_lshl_add_u32 v92, v92, 4, s80
    s_add_u32 m0, s80, 0
    s_mov_b32 s82, 0
    buffer_load_dwordx4 v92, s[84:87], s82 offen offset:0 lds
    buffer_load_dwordx4 v92, s[84:87], s82 offen offset:1024 lds
    buffer_load_dwordx4 v92, s[84:87], s82 offen offset:2048 lds
    buffer_load_dwordx4 v92, s[84:87], s82 offen offset:3072 lds
    s_add_u32 m0, s80, 4096
    s_mov_b32 s82, 4096
    buffer_load_dwordx4 v92, s[84:87], s82 offen offset:0 lds
    buffer_load_dwordx4 v92, s[84:87], s82 offen offset:1024 lds
    buffer_load_dwordx4 v92, s[84:87], s82 offen offset:2048 lds
    s_add_u32 m0, s80, 45056
    s_mov_b32 s82, 28672
    buffer_load_dwordx4 v92, s[84:87], s82 offen offset:0 lds
    buffer_load_dwordx4 v92, s[84:87], s82 offen offset:1024 lds
    buffer_load_dwordx4 v92, s[84:87], s82 offen offset:2048 lds
    buffer_load_dwordx4 v92, s[84:87], s82 offen offset:3072 lds
    s_add_u32 m0, s80, 49152
    s_mov_b32 s82, 32768
    buffer_load_dwordx4 v92, s[84:87], s82 offen offset:0 lds
    buffer_load_dwordx4 v92, s[84:87], s82 offen offset:1024 lds
    buffer_load_dwordx4 v92, s[84:87], s82 offen offset:2048 lds
    s_add_u32 m0, s80, 90112
    s_mov_b32 s82, 57344
    buffer_load_dwordx4 v92, s[84:87], s82 offen offset:0 lds
    buffer_load_dwordx4 v92, s[84:87], s82 offen offset:1024 lds
    buffer_load_dwordx4 v92, s[84:87], s82 offen offset:2048 lds
    buffer_load_dwordx4 v92, s[84:87], s82 offen offset:3072 lds
    s_add_u32 m0, s80, 94208
    s_mov_b32 s82, 61440
    buffer_load_dwordx4 v92, s[84:87], s82 offen offset:0 lds
    buffer_load_dwordx4 v92, s[84:87], s82 offen offset:1024 lds
    s_mul_i32 s28, s32, 7168
    v_add_u32 v4, s28, v8
    s_lshl_b32 s28, s33, 12
    s_add_u32 s28, s28, 28672
    v_add_u32 v5, s28, v8
    v_mov_b32 v6, v4
    v_mov_b32 v7, v5
    s_mov_b32 s42, 0
    s_mov_b32 s43, 15
    s_barrier
    s_add_u32 m0, s35, 0
    s_mov_b32 s46, 0
    buffer_load_dwordx4 v3, s[12:15], s46 offen offset:0 lds
    buffer_load_dwordx4 v3, s[12:15], s46 offen offset:1024 lds
    buffer_load_dwordx4 v3, s[12:15], s46 offen offset:2048 lds
    buffer_load_dwordx4 v3, s[12:15], s46 offen offset:3072 lds
    s_add_u32 m0, s35, 45056
    s_mov_b32 s46, 16384
    buffer_load_dwordx4 v3, s[12:15], s46 offen offset:0 lds
    buffer_load_dwordx4 v3, s[12:15], s46 offen offset:1024 lds
    buffer_load_dwordx4 v3, s[12:15], s46 offen offset:2048 lds
    buffer_load_dwordx4 v3, s[12:15], s46 offen offset:3072 lds
    s_add_u32 m0, s36, s34
    s_add_u32 m0, m0, 0x1000
    s_waitcnt vmcnt(28)
    v_lshlrev_b32 v16, 16, v172
    v_and_b32 v17, 0xffff0000, v172
    v_lshlrev_b32 v18, 16, v173
    v_and_b32 v19, 0xffff0000, v173
    v_mov_b32 v20, v16
    v_mov_b32 v21, v17
    v_mov_b32 v22, v18
    v_mov_b32 v23, v19
    v_mov_b32 v24, v16
    v_mov_b32 v25, v17
    v_mov_b32 v26, v18
    v_mov_b32 v27, v19
    v_mov_b32 v28, v16
    v_mov_b32 v29, v17
    v_mov_b32 v30, v18
    v_mov_b32 v31, v19
    v_lshlrev_b32 v32, 16, v174
    v_and_b32 v33, 0xffff0000, v174
    v_lshlrev_b32 v34, 16, v175
    v_and_b32 v35, 0xffff0000, v175
    v_mov_b32 v36, v32
    v_mov_b32 v37, v33
    v_mov_b32 v38, v34
    v_mov_b32 v39, v35
    v_mov_b32 v40, v32
    v_mov_b32 v41, v33
    v_mov_b32 v42, v34
    v_mov_b32 v43, v35
    v_mov_b32 v44, v32
    v_mov_b32 v45, v33
    v_mov_b32 v46, v34
    v_mov_b32 v47, v35
    v_lshlrev_b32 v48, 16, v176
    v_and_b32 v49, 0xffff0000, v176
    v_lshlrev_b32 v50, 16, v177
    v_and_b32 v51, 0xffff0000, v177
    v_mov_b32 v52, v48
    v_mov_b32 v53, v49
    v_mov_b32 v54, v50
    v_mov_b32 v55, v51
    v_mov_b32 v56, v48
    v_mov_b32 v57, v49
    v_mov_b32 v58, v50
    v_mov_b32 v59, v51
    v_mov_b32 v60, v48
    v_mov_b32 v61, v49
    v_mov_b32 v62, v50
    v_mov_b32 v63, v51
    v_lshlrev_b32 v64, 16, v178
    v_and_b32 v65, 0xffff0000, v178
    v_lshlrev_b32 v66, 16, v179
    v_and_b32 v67, 0xffff0000, v179
    v_mov_b32 v68, v64
    v_mov_b32 v69, v65
    v_mov_b32 v70, v66
    v_mov_b32 v71, v67
    v_mov_b32 v72, v64
    v_mov_b32 v73, v65
    v_mov_b32 v74, v66
    v_mov_b32 v75, v67
    v_mov_b32 v76, v64
    v_mov_b32 v77, v65
    v_mov_b32 v78, v66
    v_mov_b32 v79, v67
    v_lshlrev_b32 v80, 16, v180
    v_and_b32 v81, 0xffff0000, v180
    v_lshlrev_b32 v82, 16, v181
    v_and_b32 v83, 0xffff0000, v181
    v_mov_b32 v84, v80
    v_mov_b32 v85, v81
    v_mov_b32 v86, v82
    v_mov_b32 v87, v83
    v_mov_b32 v88, v80
    v_mov_b32 v89, v81
    v_mov_b32 v90, v82
    v_mov_b32 v91, v83
    v_mov_b32 v92, v80
    v_mov_b32 v93, v81
    v_mov_b32 v94, v82
    v_mov_b32 v95, v83
    v_lshlrev_b32 v96, 16, v182
    v_and_b32 v97, 0xffff0000, v182
    v_lshlrev_b32 v98, 16, v183
    v_and_b32 v99, 0xffff0000, v183
    v_mov_b32 v100, v96
    v_mov_b32 v101, v97
    v_mov_b32 v102, v98
    v_mov_b32 v103, v99
    v_mov_b32 v104, v96
    v_mov_b32 v105, v97
    v_mov_b32 v106, v98
    v_mov_b32 v107, v99
    v_mov_b32 v108, v96
    v_mov_b32 v109, v97
    v_mov_b32 v110, v98
    v_mov_b32 v111, v99
    v_lshlrev_b32 v112, 16, v184
    v_and_b32 v113, 0xffff0000, v184
    v_lshlrev_b32 v114, 16, v185
    v_and_b32 v115, 0xffff0000, v185
    v_mov_b32 v116, v112
    v_mov_b32 v117, v113
    v_mov_b32 v118, v114
    v_mov_b32 v119, v115
    v_mov_b32 v120, v112
    v_mov_b32 v121, v113
    v_mov_b32 v122, v114
    v_mov_b32 v123, v115
    v_mov_b32 v124, v112
    v_mov_b32 v125, v113
    v_mov_b32 v126, v114
    v_mov_b32 v127, v115
    s_waitcnt vmcnt(4)
    s_barrier
    ds_read_b128 v[144:147], v6 offset:0
    ds_read_b128 v[128:131], v7 offset:0
    ds_read_b128 v[132:135], v7 offset:1024
    ds_read_b128 v[136:139], v7 offset:2048
    ds_read_b128 v[140:143], v7 offset:3072
    ds_read_b128 v[148:151], v6 offset:1024
    ds_read_b128 v[152:155], v6 offset:2048
    ds_read_b128 v[156:159], v6 offset:3072
    ds_read_b128 v[160:163], v6 offset:4096
    ds_read_b128 v[164:167], v6 offset:5120
    ds_read_b128 v[168:171], v6 offset:6144
    s_waitcnt lgkmcnt(0)
    v_mfma_f32_16x16x32_bf16 v[16:19], v[144:147], v[128:131], v[16:19]
    ds_read_b128 v[188:191], v6 offset:14336
    v_mfma_f32_16x16x32_bf16 v[20:23], v[144:147], v[132:135], v[20:23]
    ds_read_b128 v[172:175], v7 offset:8192
    v_mfma_f32_16x16x32_bf16 v[24:27], v[144:147], v[136:139], v[24:27]
    ds_read_b128 v[176:179], v7 offset:9216
    buffer_load_dwordx4 v2, s[8:11], s38 offen offset:2048 lds
    v_mfma_f32_16x16x32_bf16 v[28:31], v[144:147], v[140:143], v[28:31]
    ds_read_b128 v[180:183], v7 offset:10240
    v_mfma_f32_16x16x32_bf16 v[32:35], v[148:151], v[128:131], v[32:35]
    ds_read_b128 v[184:187], v7 offset:11264
    v_mfma_f32_16x16x32_bf16 v[36:39], v[148:151], v[132:135], v[36:39]
    ds_read_b128 v[192:195], v6 offset:15360
    v_mfma_f32_16x16x32_bf16 v[40:43], v[148:151], v[136:139], v[40:43]
    ds_read_b128 v[196:199], v6 offset:16384
    v_mfma_f32_16x16x32_bf16 v[44:47], v[148:151], v[140:143], v[44:47]
    ds_read_b128 v[200:203], v6 offset:17408
    s_add_u32 m0, s36, s35
    v_mfma_f32_16x16x32_bf16 v[48:51], v[152:155], v[128:131], v[48:51]
    ds_read_b128 v[204:207], v6 offset:18432
    buffer_load_dwordx4 v3, s[12:15], s39 offen offset:0 lds
    v_mfma_f32_16x16x32_bf16 v[52:55], v[152:155], v[132:135], v[52:55]
    ds_read_b128 v[208:211], v6 offset:19456
    v_mfma_f32_16x16x32_bf16 v[56:59], v[152:155], v[136:139], v[56:59]
    ds_read_b128 v[212:215], v6 offset:20480
    v_mfma_f32_16x16x32_bf16 v[60:63], v[152:155], v[140:143], v[60:63]
    v_mfma_f32_16x16x32_bf16 v[64:67], v[156:159], v[128:131], v[64:67]
    v_mfma_f32_16x16x32_bf16 v[68:71], v[156:159], v[132:135], v[68:71]
    v_mfma_f32_16x16x32_bf16 v[72:75], v[156:159], v[136:139], v[72:75]
    buffer_load_dwordx4 v3, s[12:15], s39 offen offset:1024 lds
    v_mfma_f32_16x16x32_bf16 v[76:79], v[156:159], v[140:143], v[76:79]
    v_mfma_f32_16x16x32_bf16 v[80:83], v[160:163], v[128:131], v[80:83]
    v_mfma_f32_16x16x32_bf16 v[84:87], v[160:163], v[132:135], v[84:87]
    v_mfma_f32_16x16x32_bf16 v[88:91], v[160:163], v[136:139], v[88:91]
    v_mfma_f32_16x16x32_bf16 v[92:95], v[160:163], v[140:143], v[92:95]
    buffer_load_dwordx4 v3, s[12:15], s39 offen offset:2048 lds
    v_mfma_f32_16x16x32_bf16 v[96:99], v[164:167], v[128:131], v[96:99]
    v_mfma_f32_16x16x32_bf16 v[100:103], v[164:167], v[132:135], v[100:103]
    v_mfma_f32_16x16x32_bf16 v[104:107], v[164:167], v[136:139], v[104:107]
    v_mfma_f32_16x16x32_bf16 v[108:111], v[164:167], v[140:143], v[108:111]
    v_mfma_f32_16x16x32_bf16 v[112:115], v[168:171], v[128:131], v[112:115]
    v_mfma_f32_16x16x32_bf16 v[116:119], v[168:171], v[132:135], v[116:119]
    buffer_load_dwordx4 v3, s[12:15], s39 offen offset:3072 lds
    v_mfma_f32_16x16x32_bf16 v[120:123], v[168:171], v[136:139], v[120:123]
    v_mfma_f32_16x16x32_bf16 v[124:127], v[168:171], v[140:143], v[124:127]
    s_add_u32 s36, s36, 45056
    s_cmp_eq_u32 s36, 135168
    s_cselect_b32 s36, 0, s36
    s_add_u32 s37, s37, 28672
    s_add_u32 s38, s38, 28672
    s_add_u32 s39, s39, 0x4000
    s_add_u32 s42, s42, 45056
    s_cmp_eq_u32 s42, 135168
    s_cselect_b32 s42, 0, s42
    v_add_u32 v6, s42, v4
    v_add_u32 v7, s42, v5
    s_waitcnt vmcnt(5) lgkmcnt(0)
    s_barrier
    v_mfma_f32_16x16x32_bf16 v[16:19], v[188:191], v[172:175], v[16:19]
    ds_read_b128 v[144:147], v6 offset:0
    v_mfma_f32_16x16x32_bf16 v[20:23], v[188:191], v[176:179], v[20:23]
    ds_read_b128 v[128:131], v7 offset:0
    s_add_u32 m0, s36, s34
    v_mfma_f32_16x16x32_bf16 v[24:27], v[188:191], v[180:183], v[24:27]
    ds_read_b128 v[132:135], v7 offset:1024
    buffer_load_dwordx4 v2, s[8:11], s37 offen offset:0 lds
    v_mfma_f32_16x16x32_bf16 v[28:31], v[188:191], v[184:187], v[28:31]
    ds_read_b128 v[136:139], v7 offset:2048
    v_mfma_f32_16x16x32_bf16 v[32:35], v[192:195], v[172:175], v[32:35]
    ds_read_b128 v[140:143], v7 offset:3072
    v_mfma_f32_16x16x32_bf16 v[36:39], v[192:195], v[176:179], v[36:39]
    ds_read_b128 v[148:151], v6 offset:1024
    v_mfma_f32_16x16x32_bf16 v[40:43], v[192:195], v[180:183], v[40:43]
    ds_read_b128 v[152:155], v6 offset:2048
    v_mfma_f32_16x16x32_bf16 v[44:47], v[192:195], v[184:187], v[44:47]
    ds_read_b128 v[156:159], v6 offset:3072
    buffer_load_dwordx4 v2, s[8:11], s37 offen offset:1024 lds
    v_mfma_f32_16x16x32_bf16 v[48:51], v[196:199], v[172:175], v[48:51]
    ds_read_b128 v[160:163], v6 offset:4096
    v_mfma_f32_16x16x32_bf16 v[52:55], v[196:199], v[176:179], v[52:55]
    ds_read_b128 v[164:167], v6 offset:5120
    v_mfma_f32_16x16x32_bf16 v[56:59], v[196:199], v[180:183], v[56:59]
    ds_read_b128 v[168:171], v6 offset:6144
    v_mfma_f32_16x16x32_bf16 v[60:63], v[196:199], v[184:187], v[60:63]
    buffer_load_dwordx4 v2, s[8:11], s37 offen offset:2048 lds
    v_mfma_f32_16x16x32_bf16 v[64:67], v[200:203], v[172:175], v[64:67]
    v_mfma_f32_16x16x32_bf16 v[68:71], v[200:203], v[176:179], v[68:71]
    v_mfma_f32_16x16x32_bf16 v[72:75], v[200:203], v[180:183], v[72:75]
    v_mfma_f32_16x16x32_bf16 v[76:79], v[200:203], v[184:187], v[76:79]
    v_mfma_f32_16x16x32_bf16 v[80:83], v[204:207], v[172:175], v[80:83]
    buffer_load_dwordx4 v2, s[8:11], s37 offen offset:3072 lds
    v_mfma_f32_16x16x32_bf16 v[84:87], v[204:207], v[176:179], v[84:87]
    v_mfma_f32_16x16x32_bf16 v[88:91], v[204:207], v[180:183], v[88:91]
    v_mfma_f32_16x16x32_bf16 v[92:95], v[204:207], v[184:187], v[92:95]
    v_mfma_f32_16x16x32_bf16 v[96:99], v[208:211], v[172:175], v[96:99]
    s_add_u32 m0, m0, 0x1000
    v_mfma_f32_16x16x32_bf16 v[100:103], v[208:211], v[176:179], v[100:103]
    buffer_load_dwordx4 v2, s[8:11], s38 offen offset:0 lds
    v_mfma_f32_16x16x32_bf16 v[104:107], v[208:211], v[180:183], v[104:107]
    v_mfma_f32_16x16x32_bf16 v[108:111], v[208:211], v[184:187], v[108:111]
    v_mfma_f32_16x16x32_bf16 v[112:115], v[212:215], v[172:175], v[112:115]
    v_mfma_f32_16x16x32_bf16 v[116:119], v[212:215], v[176:179], v[116:119]
    buffer_load_dwordx4 v2, s[8:11], s38 offen offset:1024 lds
    v_mfma_f32_16x16x32_bf16 v[120:123], v[212:215], v[180:183], v[120:123]
    v_mfma_f32_16x16x32_bf16 v[124:127], v[212:215], v[184:187], v[124:127]
.p2align 3
Lg1b_loop:
    s_waitcnt lgkmcnt(0)
    s_nop 0
    v_mfma_f32_16x16x32_bf16 v[16:19], v[144:147], v[128:131], v[16:19]
    ds_read_b128 v[188:191], v6 offset:14336
    v_mfma_f32_16x16x32_bf16 v[20:23], v[144:147], v[132:135], v[20:23]
    ds_read_b128 v[172:175], v7 offset:8192
    v_mfma_f32_16x16x32_bf16 v[24:27], v[144:147], v[136:139], v[24:27]
    ds_read_b128 v[176:179], v7 offset:9216
    buffer_load_dwordx4 v2, s[8:11], s38 offen offset:2048 lds
    v_mfma_f32_16x16x32_bf16 v[28:31], v[144:147], v[140:143], v[28:31]
    ds_read_b128 v[180:183], v7 offset:10240
    v_mfma_f32_16x16x32_bf16 v[32:35], v[148:151], v[128:131], v[32:35]
    ds_read_b128 v[184:187], v7 offset:11264
    v_mfma_f32_16x16x32_bf16 v[36:39], v[148:151], v[132:135], v[36:39]
    ds_read_b128 v[192:195], v6 offset:15360
    v_mfma_f32_16x16x32_bf16 v[40:43], v[148:151], v[136:139], v[40:43]
    ds_read_b128 v[196:199], v6 offset:16384
    v_mfma_f32_16x16x32_bf16 v[44:47], v[148:151], v[140:143], v[44:47]
    ds_read_b128 v[200:203], v6 offset:17408
    s_add_u32 m0, s36, s35
    s_nop 0
    v_mfma_f32_16x16x32_bf16 v[48:51], v[152:155], v[128:131], v[48:51]
    ds_read_b128 v[204:207], v6 offset:18432
    buffer_load_dwordx4 v3, s[12:15], s39 offen offset:0 lds
    v_mfma_f32_16x16x32_bf16 v[52:55], v[152:155], v[132:135], v[52:55]
    ds_read_b128 v[208:211], v6 offset:19456
    v_mfma_f32_16x16x32_bf16 v[56:59], v[152:155], v[136:139], v[56:59]
    ds_read_b128 v[212:215], v6 offset:20480
    v_mfma_f32_16x16x32_bf16 v[60:63], v[152:155], v[140:143], v[60:63]
    v_mfma_f32_16x16x32_bf16 v[64:67], v[156:159], v[128:131], v[64:67]
    v_mfma_f32_16x16x32_bf16 v[68:71], v[156:159], v[132:135], v[68:71]
    v_mfma_f32_16x16x32_bf16 v[72:75], v[156:159], v[136:139], v[72:75]
    buffer_load_dwordx4 v3, s[12:15], s39 offen offset:1024 lds
    v_mfma_f32_16x16x32_bf16 v[76:79], v[156:159], v[140:143], v[76:79]
    v_mfma_f32_16x16x32_bf16 v[80:83], v[160:163], v[128:131], v[80:83]
    v_mfma_f32_16x16x32_bf16 v[84:87], v[160:163], v[132:135], v[84:87]
    v_mfma_f32_16x16x32_bf16 v[88:91], v[160:163], v[136:139], v[88:91]
    v_mfma_f32_16x16x32_bf16 v[92:95], v[160:163], v[140:143], v[92:95]
    buffer_load_dwordx4 v3, s[12:15], s39 offen offset:2048 lds
    v_mfma_f32_16x16x32_bf16 v[96:99], v[164:167], v[128:131], v[96:99]
    v_mfma_f32_16x16x32_bf16 v[100:103], v[164:167], v[132:135], v[100:103]
    v_mfma_f32_16x16x32_bf16 v[104:107], v[164:167], v[136:139], v[104:107]
    v_mfma_f32_16x16x32_bf16 v[108:111], v[164:167], v[140:143], v[108:111]
    v_mfma_f32_16x16x32_bf16 v[112:115], v[168:171], v[128:131], v[112:115]
    v_mfma_f32_16x16x32_bf16 v[116:119], v[168:171], v[132:135], v[116:119]
    buffer_load_dwordx4 v3, s[12:15], s39 offen offset:3072 lds
    v_mfma_f32_16x16x32_bf16 v[120:123], v[168:171], v[136:139], v[120:123]
    v_mfma_f32_16x16x32_bf16 v[124:127], v[168:171], v[140:143], v[124:127]
    s_add_u32 s36, s36, 45056
    s_cmp_eq_u32 s36, 135168
    s_cselect_b32 s36, 0, s36
    s_nop 0
    s_add_u32 s37, s37, 28672
    s_add_u32 s38, s38, 28672
    s_add_u32 s39, s39, 0x4000
    s_add_u32 s42, s42, 45056
    s_cmp_eq_u32 s42, 135168
    s_cselect_b32 s42, 0, s42
    v_add_u32 v6, s42, v4
    v_add_u32 v7, s42, v5
    s_waitcnt vmcnt(11) lgkmcnt(0)
    s_barrier
    s_nop 0
    v_mfma_f32_16x16x32_bf16 v[16:19], v[188:191], v[172:175], v[16:19]
    ds_read_b128 v[144:147], v6 offset:0
    v_mfma_f32_16x16x32_bf16 v[20:23], v[188:191], v[176:179], v[20:23]
    ds_read_b128 v[128:131], v7 offset:0
    s_add_u32 m0, s36, s34
    s_nop 0
    v_mfma_f32_16x16x32_bf16 v[24:27], v[188:191], v[180:183], v[24:27]
    ds_read_b128 v[132:135], v7 offset:1024
    buffer_load_dwordx4 v2, s[8:11], s37 offen offset:0 lds
    v_mfma_f32_16x16x32_bf16 v[28:31], v[188:191], v[184:187], v[28:31]
    ds_read_b128 v[136:139], v7 offset:2048
    v_mfma_f32_16x16x32_bf16 v[32:35], v[192:195], v[172:175], v[32:35]
    ds_read_b128 v[140:143], v7 offset:3072
    v_mfma_f32_16x16x32_bf16 v[36:39], v[192:195], v[176:179], v[36:39]
    ds_read_b128 v[148:151], v6 offset:1024
    v_mfma_f32_16x16x32_bf16 v[40:43], v[192:195], v[180:183], v[40:43]
    ds_read_b128 v[152:155], v6 offset:2048
    v_mfma_f32_16x16x32_bf16 v[44:47], v[192:195], v[184:187], v[44:47]
    ds_read_b128 v[156:159], v6 offset:3072
    buffer_load_dwordx4 v2, s[8:11], s37 offen offset:1024 lds
    v_mfma_f32_16x16x32_bf16 v[48:51], v[196:199], v[172:175], v[48:51]
    ds_read_b128 v[160:163], v6 offset:4096
    v_mfma_f32_16x16x32_bf16 v[52:55], v[196:199], v[176:179], v[52:55]
    ds_read_b128 v[164:167], v6 offset:5120
    v_mfma_f32_16x16x32_bf16 v[56:59], v[196:199], v[180:183], v[56:59]
    ds_read_b128 v[168:171], v6 offset:6144
    v_mfma_f32_16x16x32_bf16 v[60:63], v[196:199], v[184:187], v[60:63]
    buffer_load_dwordx4 v2, s[8:11], s37 offen offset:2048 lds
    v_mfma_f32_16x16x32_bf16 v[64:67], v[200:203], v[172:175], v[64:67]
    v_mfma_f32_16x16x32_bf16 v[68:71], v[200:203], v[176:179], v[68:71]
    v_mfma_f32_16x16x32_bf16 v[72:75], v[200:203], v[180:183], v[72:75]
    v_mfma_f32_16x16x32_bf16 v[76:79], v[200:203], v[184:187], v[76:79]
    v_mfma_f32_16x16x32_bf16 v[80:83], v[204:207], v[172:175], v[80:83]
    buffer_load_dwordx4 v2, s[8:11], s37 offen offset:3072 lds
    v_mfma_f32_16x16x32_bf16 v[84:87], v[204:207], v[176:179], v[84:87]
    v_mfma_f32_16x16x32_bf16 v[88:91], v[204:207], v[180:183], v[88:91]
    v_mfma_f32_16x16x32_bf16 v[92:95], v[204:207], v[184:187], v[92:95]
    v_mfma_f32_16x16x32_bf16 v[96:99], v[208:211], v[172:175], v[96:99]
    s_add_u32 m0, m0, 0x1000
    v_mfma_f32_16x16x32_bf16 v[100:103], v[208:211], v[176:179], v[100:103]
    buffer_load_dwordx4 v2, s[8:11], s38 offen offset:0 lds
    v_mfma_f32_16x16x32_bf16 v[104:107], v[208:211], v[180:183], v[104:107]
    v_mfma_f32_16x16x32_bf16 v[108:111], v[208:211], v[184:187], v[108:111]
    v_mfma_f32_16x16x32_bf16 v[112:115], v[212:215], v[172:175], v[112:115]
    v_mfma_f32_16x16x32_bf16 v[116:119], v[212:215], v[176:179], v[116:119]
    buffer_load_dwordx4 v2, s[8:11], s38 offen offset:1024 lds
    v_mfma_f32_16x16x32_bf16 v[120:123], v[212:215], v[180:183], v[120:123]
    v_mfma_f32_16x16x32_bf16 v[124:127], v[212:215], v[184:187], v[124:127]
    s_sub_u32 s43, s43, 1
    s_cmp_lg_u32 s43, 0
    s_cbranch_scc1 Lg1b_loop
    s_waitcnt vmcnt(0) lgkmcnt(0)
    s_mul_i32 s28, s30, 112
    s_mul_i32 s29, s31, 7
    s_add_u32 s28, s28, s29
    s_lshl_b32 s28, s28, 13
    s_add_u32 s28, s28, 75497472
    s_add_u32 s16, s6, s28
    s_addc_u32 s17, s7, 0
    s_and_b32 s17, s17, 0xffff
    s_mov_b32 s18, 57344
    s_mov_b32 s19, 0x20000
    s_lshl_b32 s28, s32, 15
    s_lshl_b32 s29, s33, 12
    s_add_u32 s28, s28, s29
    v_add_u32 v10, s28, v8
    s_lshl_b32 s28, s32, 3
    s_add_u32 s28, s28, s29
    s_add_u32 s28, s28, 135168
    v_add_u32 v11, s28, v8
    s_lshl_b32 s28, s32, 11
    s_add_u32 s28, s28, s29
    s_add_u32 s29, s28, 135168
    v_add_u32 v12, s29, v8
    s_add_u32 s28, s28, 0x6000
    v_add_u32 v13, s28, v8
    s_movk_i32 s44, 0x2000
    s_movk_i32 s45, 0x4000
    v_max_f32 v112, 0, v112
    v_max_f32 v113, 0, v113
    v_max_f32 v114, 0, v114
    v_max_f32 v115, 0, v115
    v_pk_mul_f32 v[112:113], v[112:113], v[112:113]
    v_pk_mul_f32 v[114:115], v[114:115], v[114:115]
    v_cvt_pk_bf16_f32 v128, v112, v113
    v_cvt_pk_bf16_f32 v129, v114, v115
    ds_write_b64 v11, v[128:129] offset:0
    v_max_f32 v116, 0, v116
    v_max_f32 v117, 0, v117
    v_max_f32 v118, 0, v118
    v_max_f32 v119, 0, v119
    v_pk_mul_f32 v[116:117], v[116:117], v[116:117]
    v_pk_mul_f32 v[118:119], v[118:119], v[118:119]
    v_cvt_pk_bf16_f32 v132, v116, v117
    v_cvt_pk_bf16_f32 v133, v118, v119
    ds_write_b64 v11, v[132:133] offset:1024
    v_max_f32 v120, 0, v120
    v_max_f32 v121, 0, v121
    v_max_f32 v122, 0, v122
    v_max_f32 v123, 0, v123
    v_pk_mul_f32 v[120:121], v[120:121], v[120:121]
    v_pk_mul_f32 v[122:123], v[122:123], v[122:123]
    v_cvt_pk_bf16_f32 v136, v120, v121
    v_cvt_pk_bf16_f32 v137, v122, v123
    ds_write_b64 v11, v[136:137] offset:2048
    v_max_f32 v124, 0, v124
    v_max_f32 v125, 0, v125
    v_max_f32 v126, 0, v126
    v_max_f32 v127, 0, v127
    v_pk_mul_f32 v[124:125], v[124:125], v[124:125]
    v_pk_mul_f32 v[126:127], v[126:127], v[126:127]
    v_cvt_pk_bf16_f32 v140, v124, v125
    v_cvt_pk_bf16_f32 v141, v126, v127
    ds_write_b64 v11, v[140:141] offset:3072
    v_max_f32 v16, 0, v16
    v_max_f32 v17, 0, v17
    v_max_f32 v18, 0, v18
    v_max_f32 v19, 0, v19
    v_pk_mul_f32 v[16:17], v[16:17], v[16:17]
    v_pk_mul_f32 v[18:19], v[18:19], v[18:19]
    v_cvt_pk_bf16_f32 v144, v16, v17
    v_cvt_pk_bf16_f32 v145, v18, v19
    v_max_f32 v32, 0, v32
    v_max_f32 v33, 0, v33
    v_max_f32 v34, 0, v34
    v_max_f32 v35, 0, v35
    v_pk_mul_f32 v[32:33], v[32:33], v[32:33]
    v_pk_mul_f32 v[34:35], v[34:35], v[34:35]
    v_cvt_pk_bf16_f32 v146, v32, v33
    v_cvt_pk_bf16_f32 v147, v34, v35
    buffer_store_dwordx4 v[144:147], v10, s[16:19], 0 offen offset:0 sc1
    v_max_f32 v20, 0, v20
    v_max_f32 v21, 0, v21
    v_max_f32 v22, 0, v22
    v_max_f32 v23, 0, v23
    v_pk_mul_f32 v[20:21], v[20:21], v[20:21]
    v_pk_mul_f32 v[22:23], v[22:23], v[22:23]
    v_cvt_pk_bf16_f32 v148, v20, v21
    v_cvt_pk_bf16_f32 v149, v22, v23
    v_max_f32 v36, 0, v36
    v_max_f32 v37, 0, v37
    v_max_f32 v38, 0, v38
    v_max_f32 v39, 0, v39
    v_pk_mul_f32 v[36:37], v[36:37], v[36:37]
    v_pk_mul_f32 v[38:39], v[38:39], v[38:39]
    v_cvt_pk_bf16_f32 v150, v36, v37
    v_cvt_pk_bf16_f32 v151, v38, v39
    buffer_store_dwordx4 v[148:151], v10, s[16:19], 0 offen offset:1024 sc1
    v_max_f32 v24, 0, v24
    v_max_f32 v25, 0, v25
    v_max_f32 v26, 0, v26
    v_max_f32 v27, 0, v27
    v_pk_mul_f32 v[24:25], v[24:25], v[24:25]
    v_pk_mul_f32 v[26:27], v[26:27], v[26:27]
    v_cvt_pk_bf16_f32 v152, v24, v25
    v_cvt_pk_bf16_f32 v153, v26, v27
    v_max_f32 v40, 0, v40
    v_max_f32 v41, 0, v41
    v_max_f32 v42, 0, v42
    v_max_f32 v43, 0, v43
    v_pk_mul_f32 v[40:41], v[40:41], v[40:41]
    v_pk_mul_f32 v[42:43], v[42:43], v[42:43]
    v_cvt_pk_bf16_f32 v154, v40, v41
    v_cvt_pk_bf16_f32 v155, v42, v43
    buffer_store_dwordx4 v[152:155], v10, s[16:19], 0 offen offset:2048 sc1
    v_max_f32 v28, 0, v28
    v_max_f32 v29, 0, v29
    v_max_f32 v30, 0, v30
    v_max_f32 v31, 0, v31
    v_pk_mul_f32 v[28:29], v[28:29], v[28:29]
    v_pk_mul_f32 v[30:31], v[30:31], v[30:31]
    v_cvt_pk_bf16_f32 v156, v28, v29
    v_cvt_pk_bf16_f32 v157, v30, v31
    v_max_f32 v44, 0, v44
    v_max_f32 v45, 0, v45
    v_max_f32 v46, 0, v46
    v_max_f32 v47, 0, v47
    v_pk_mul_f32 v[44:45], v[44:45], v[44:45]
    v_pk_mul_f32 v[46:47], v[46:47], v[46:47]
    v_cvt_pk_bf16_f32 v158, v44, v45
    v_cvt_pk_bf16_f32 v159, v46, v47
    buffer_store_dwordx4 v[156:159], v10, s[16:19], 0 offen offset:3072 sc1
    s_waitcnt lgkmcnt(0)
    s_barrier
    ds_read_b128 v[128:131], v12 offset:0
    ds_read_b128 v[132:135], v12 offset:1024
    v_max_f32 v48, 0, v48
    v_max_f32 v49, 0, v49
    v_max_f32 v50, 0, v50
    v_max_f32 v51, 0, v51
    v_pk_mul_f32 v[48:49], v[48:49], v[48:49]
    v_pk_mul_f32 v[50:51], v[50:51], v[50:51]
    v_cvt_pk_bf16_f32 v160, v48, v49
    v_cvt_pk_bf16_f32 v161, v50, v51
    v_max_f32 v64, 0, v64
    v_max_f32 v65, 0, v65
    v_max_f32 v66, 0, v66
    v_max_f32 v67, 0, v67
    v_pk_mul_f32 v[64:65], v[64:65], v[64:65]
    v_pk_mul_f32 v[66:67], v[66:67], v[66:67]
    v_cvt_pk_bf16_f32 v162, v64, v65
    v_cvt_pk_bf16_f32 v163, v66, v67
    buffer_store_dwordx4 v[160:163], v10, s[16:19], s44 offen offset:0 sc1
    v_max_f32 v52, 0, v52
    v_max_f32 v53, 0, v53
    v_max_f32 v54, 0, v54
    v_max_f32 v55, 0, v55
    v_pk_mul_f32 v[52:53], v[52:53], v[52:53]
    v_pk_mul_f32 v[54:55], v[54:55], v[54:55]
    v_cvt_pk_bf16_f32 v164, v52, v53
    v_cvt_pk_bf16_f32 v165, v54, v55
    v_max_f32 v68, 0, v68
    v_max_f32 v69, 0, v69
    v_max_f32 v70, 0, v70
    v_max_f32 v71, 0, v71
    v_pk_mul_f32 v[68:69], v[68:69], v[68:69]
    v_pk_mul_f32 v[70:71], v[70:71], v[70:71]
    v_cvt_pk_bf16_f32 v166, v68, v69
    v_cvt_pk_bf16_f32 v167, v70, v71
    buffer_store_dwordx4 v[164:167], v10, s[16:19], s44 offen offset:1024 sc1
    v_max_f32 v56, 0, v56
    v_max_f32 v57, 0, v57
    v_max_f32 v58, 0, v58
    v_max_f32 v59, 0, v59
    v_pk_mul_f32 v[56:57], v[56:57], v[56:57]
    v_pk_mul_f32 v[58:59], v[58:59], v[58:59]
    v_cvt_pk_bf16_f32 v168, v56, v57
    v_cvt_pk_bf16_f32 v169, v58, v59
    v_max_f32 v72, 0, v72
    v_max_f32 v73, 0, v73
    v_max_f32 v74, 0, v74
    v_max_f32 v75, 0, v75
    v_pk_mul_f32 v[72:73], v[72:73], v[72:73]
    v_pk_mul_f32 v[74:75], v[74:75], v[74:75]
    v_cvt_pk_bf16_f32 v170, v72, v73
    v_cvt_pk_bf16_f32 v171, v74, v75
    buffer_store_dwordx4 v[168:171], v10, s[16:19], s44 offen offset:2048 sc1
    v_max_f32 v60, 0, v60
    v_max_f32 v61, 0, v61
    v_max_f32 v62, 0, v62
    v_max_f32 v63, 0, v63
    v_pk_mul_f32 v[60:61], v[60:61], v[60:61]
    v_pk_mul_f32 v[62:63], v[62:63], v[62:63]
    v_cvt_pk_bf16_f32 v172, v60, v61
    v_cvt_pk_bf16_f32 v173, v62, v63
    v_max_f32 v76, 0, v76
    v_max_f32 v77, 0, v77
    v_max_f32 v78, 0, v78
    v_max_f32 v79, 0, v79
    v_pk_mul_f32 v[76:77], v[76:77], v[76:77]
    v_pk_mul_f32 v[78:79], v[78:79], v[78:79]
    v_cvt_pk_bf16_f32 v174, v76, v77
    v_cvt_pk_bf16_f32 v175, v78, v79
    buffer_store_dwordx4 v[172:175], v10, s[16:19], s44 offen offset:3072 sc1
    s_waitcnt lgkmcnt(0)
    buffer_store_dwordx4 v[128:131], v13, s[16:19], 0 offen offset:0 sc1
    buffer_store_dwordx4 v[132:135], v13, s[16:19], 0 offen offset:1024 sc1
    v_max_f32 v80, 0, v80
    v_max_f32 v81, 0, v81
    v_max_f32 v82, 0, v82
    v_max_f32 v83, 0, v83
    v_pk_mul_f32 v[80:81], v[80:81], v[80:81]
    v_pk_mul_f32 v[82:83], v[82:83], v[82:83]
    v_cvt_pk_bf16_f32 v176, v80, v81
    v_cvt_pk_bf16_f32 v177, v82, v83
    v_max_f32 v96, 0, v96
    v_max_f32 v97, 0, v97
    v_max_f32 v98, 0, v98
    v_max_f32 v99, 0, v99
    v_pk_mul_f32 v[96:97], v[96:97], v[96:97]
    v_pk_mul_f32 v[98:99], v[98:99], v[98:99]
    v_cvt_pk_bf16_f32 v178, v96, v97
    v_cvt_pk_bf16_f32 v179, v98, v99
    buffer_store_dwordx4 v[176:179], v10, s[16:19], s45 offen offset:0 sc1
    v_max_f32 v84, 0, v84
    v_max_f32 v85, 0, v85
    v_max_f32 v86, 0, v86
    v_max_f32 v87, 0, v87
    v_pk_mul_f32 v[84:85], v[84:85], v[84:85]
    v_pk_mul_f32 v[86:87], v[86:87], v[86:87]
    v_cvt_pk_bf16_f32 v180, v84, v85
    v_cvt_pk_bf16_f32 v181, v86, v87
    v_max_f32 v100, 0, v100
    v_max_f32 v101, 0, v101
    v_max_f32 v102, 0, v102
    v_max_f32 v103, 0, v103
    v_pk_mul_f32 v[100:101], v[100:101], v[100:101]
    v_pk_mul_f32 v[102:103], v[102:103], v[102:103]
    v_cvt_pk_bf16_f32 v182, v100, v101
    v_cvt_pk_bf16_f32 v183, v102, v103
    buffer_store_dwordx4 v[180:183], v10, s[16:19], s45 offen offset:1024 sc1
    v_max_f32 v88, 0, v88
    v_max_f32 v89, 0, v89
    v_max_f32 v90, 0, v90
    v_max_f32 v91, 0, v91
    v_pk_mul_f32 v[88:89], v[88:89], v[88:89]
    v_pk_mul_f32 v[90:91], v[90:91], v[90:91]
    v_cvt_pk_bf16_f32 v184, v88, v89
    v_cvt_pk_bf16_f32 v185, v90, v91
    v_max_f32 v104, 0, v104
    v_max_f32 v105, 0, v105
    v_max_f32 v106, 0, v106
    v_max_f32 v107, 0, v107
    v_pk_mul_f32 v[104:105], v[104:105], v[104:105]
    v_pk_mul_f32 v[106:107], v[106:107], v[106:107]
    v_cvt_pk_bf16_f32 v186, v104, v105
    v_cvt_pk_bf16_f32 v187, v106, v107
    buffer_store_dwordx4 v[184:187], v10, s[16:19], s45 offen offset:2048 sc1
    v_max_f32 v92, 0, v92
    v_max_f32 v93, 0, v93
    v_max_f32 v94, 0, v94
    v_max_f32 v95, 0, v95
    v_pk_mul_f32 v[92:93], v[92:93], v[92:93]
    v_pk_mul_f32 v[94:95], v[94:95], v[94:95]
    v_cvt_pk_bf16_f32 v188, v92, v93
    v_cvt_pk_bf16_f32 v189, v94, v95
    v_max_f32 v108, 0, v108
    v_max_f32 v109, 0, v109
    v_max_f32 v110, 0, v110
    v_max_f32 v111, 0, v111
    v_pk_mul_f32 v[108:109], v[108:109], v[108:109]
    v_pk_mul_f32 v[110:111], v[110:111], v[110:111]
    v_cvt_pk_bf16_f32 v190, v108, v109
    v_cvt_pk_bf16_f32 v191, v110, v111
    buffer_store_dwordx4 v[188:191], v10, s[16:19], s45 offen offset:3072 sc1
    s_setprio 0
    s_waitcnt vmcnt(0)
Lg1b_fin:
    s_barrier
    v_lshrrev_b32 v2, 6, v0
    v_and_b32 v1, 63, v0
    v_readfirstlane_b32 s3, v2
    s_nop 3
    s_cmp_lt_u32 s3, 4
    s_cbranch_scc1 Lg2b_main
    s_cmp_lg_u32 s3, 4
    s_cbranch_scc1 Lg2b_nh
    s_add_u32 s64, s6, 58720256
    s_addc_u32 s65, s7, 0
    s_and_b32 s65, s65, 0xffff
    s_mov_b32 s66, 262144
    s_mov_b32 s67, 0x20000
    s_lshl_b32 s68, s2, 10
    v_mov_b32 v81, 5
    v_mov_b32 v82, 0x200
    v_and_b32 v80, 63, v0
    s_mov_b64 exec, 1
    buffer_store_dword v81, v82, s[64:67], s68 offen sc1
    s_mov_b64 exec, 0xff
    s_and_b32 s68, s2, 7
    s_lshr_b32 s69, s2, 3
    s_lshr_b32 s70, s68, 1
    s_lshl_b32 s70, s70, 2
    s_and_b32 s71, s69, 3
    s_add_u32 s70, s70, s71
    s_lshr_b32 s71, s70, 3
    s_and_b32 s70, s70, 7
    s_lshl_b32 s70, s70, 3
    s_add_u32 s70, s70, s71
    s_and_b32 s71, s68, 1
    s_lshl_b32 s71, s71, 2
    s_add_u32 s70, s70, s71
    v_lshrrev_b32 v83, 2, v80
    v_lshl_add_u32 v83, v83, 1, s70
    v_and_b32 v84, 3, v80
    v_lshl_add_u32 v83, v84, 6, v83
    v_lshl_add_u32 v83, v83, 10, v82
    s_mov_b32 s58, 0x40000
Lg2b_hp:
    buffer_load_dword v84, v83, s[64:67], 0 offen sc1
    s_sub_u32 s58, s58, 1
    s_cbranch_scc1 Lg2b_hg
    s_waitcnt vmcnt(0)
    v_cmp_gt_u32 vcc, 5, v84
    s_cbranch_vccnz Lg2b_hp
Lg2b_hg:
    s_waitcnt vmcnt(0)
    s_mov_b64 exec, -1
Lg2b_nh:
    s_barrier
    s_endpgm
Lg2b_main:
    s_setprio 3
    s_load_dwordx2 s[4:5], s[0:1], 80
    s_load_dwordx2 s[40:41], s[0:1], 88
    s_and_b32 s28, s2, 7
    s_lshr_b32 s29, s2, 3
    s_and_b32 s52, s28, 1
    s_lshr_b32 s30, s28, 1
    s_lshl_b32 s30, s30, 2
    s_and_b32 s31, s29, 3
    s_add_u32 s30, s30, s31
    s_lshr_b32 s31, s29, 2
    s_lshl_b32 s28, s31, 1
    s_add_u32 s28, s28, s52
    s_mul_i32 s28, s28, 458752
    s_add_u32 s28, s28, 7340032
    s_lshl_b32 s29, s30, 1
    s_add_u32 s29, s29, s52
    s_mul_i32 s29, s29, 458752
    s_add_u32 s29, s29, 75497472
    s_lshr_b32 s32, s3, 1
    s_and_b32 s33, s3, 1
    s_mul_i32 s34, s3, 4096
    s_lshl_b32 s35, s3, 12
    v_lshlrev_b32 v8, 4, v1
    v_add_u32 v2, s34, v8
    v_add_u32 v3, s35, v8
    s_add_u32 s35, s35, 16384
    s_waitcnt lgkmcnt(0)
    s_add_u32 s8, s6, s28
    s_addc_u32 s9, s7, 0
    s_and_b32 s9, s9, 0xffff
    s_mov_b32 s10, 458752
    s_mov_b32 s11, 0x20000
    s_add_u32 s12, s6, s29
    s_addc_u32 s13, s7, 0
    s_and_b32 s13, s13, 0xffff
    s_mov_b32 s14, 458752
    s_mov_b32 s15, 0x20000
    v_lshrrev_b32 v9, 4, v1
    s_lshl_b32 s28, s31, 8
    s_add_u32 s16, s4, s28
    s_addc_u32 s17, s5, 0
    s_and_b32 s17, s17, 0xffff
    s_mov_b32 s18, 256
    s_mov_b32 s19, 0x20000
    s_lshl_b32 s29, s30, 18
    s_add_u32 s53, s28, s29
    s_add_u32 s29, s53, 67108864
    s_sub_u32 s47, 0x40000, s28
    s_add_u32 s20, s6, s29
    s_addc_u32 s21, s7, 0
    s_and_b32 s21, s21, 0xffff
    s_mov_b32 s22, s47
    s_mov_b32 s23, 0x20000
    s_lshl_b32 s29, s32, 7
    v_lshl_add_u32 v10, v9, 4, s29
    s_lshl_b32 s29, s33, 17
    s_lshl_b32 s28, s52, 16
    s_add_u32 s29, s29, s28
    s_lshl_b32 s28, s32, 7
    s_add_u32 s29, s29, s28
    v_lshrrev_b32 v11, 3, v1
    v_and_b32 v14, 7, v1
    v_mul_u32_u24 v15, 144, v11
    v_lshl_add_u32 v11, v11, 11, s29
    v_lshl_add_u32 v11, v14, 4, v11
    s_mul_i32 s28, s3, 4608
    s_add_u32 s28, s28, 131072
    v_lshl_add_u32 v15, v14, 4, v15
    v_add_u32 v15, s28, v15
    v_and_b32 v14, 15, v1
    v_mul_u32_u24 v14, 144, v14
    v_lshl_add_u32 v14, v9, 4, v14
    v_add_u32 v14, s28, v14
    s_movk_i32 s44, 0x4000
    s_mov_b32 s45, 0x8000
    s_mov_b32 s60, 0xc000
    buffer_load_dwordx4 v[112:115], v10, s[16:19], 0 offen offset:0
    buffer_load_dwordx4 v[116:119], v10, s[16:19], 0 offen offset:64
    s_mov_b32 s36, 0
    s_mov_b32 s37, 0
    s_movk_i32 s38, 0x1000
    s_mov_b32 s39, 0
    s_add_u32 s36, s36, 32768
    s_cmp_eq_u32 s36, 131072
    s_cselect_b32 s36, 0, s36
    s_add_u32 s37, s37, 16384
    s_add_u32 s39, s39, 0x4000
    s_add_u32 s36, s36, 32768
    s_cmp_eq_u32 s36, 131072
    s_cselect_b32 s36, 0, s36
    s_add_u32 s37, s37, 16384
    s_add_u32 s39, s39, 0x4000
    s_add_u32 s36, s36, 32768
    s_cmp_eq_u32 s36, 131072
    s_cselect_b32 s36, 0, s36
    s_add_u32 s37, s37, 16384
    s_add_u32 s39, s39, 0x4000
    v_readfirstlane_b32 s80, v0
    s_and_b32 s81, s2, 7
    s_lshr_b32 s82, s2, 3
    s_nop 1
    s_lshr_b32 s80, s80, 6
    s_and_b32 s81, s81, 1
    s_lshr_b32 s82, s82, 2
    s_lshl_b32 s82, s82, 1
    s_add_u32 s81, s81, s82
    s_mul_i32 s81, s81, 458752
    s_add_u32 s81, s81, 7340032
    s_add_u32 s84, s6, s81
    s_addc_u32 s85, s7, 0
    s_and_b32 s85, s85, 0xffff
    s_mov_b32 s86, 458752
    s_mov_b32 s87, 0x20000
    s_mul_i32 s80, s80, 4096
    v_and_b32 v92, 63, v0
    v_lshl_add_u32 v92, v92, 4, s80
    s_add_u32 m0, s80, 0
    s_mov_b32 s82, 0
    buffer_load_dwordx4 v92, s[84:87], s82 offen offset:0 lds
    buffer_load_dwordx4 v92, s[84:87], s82 offen offset:1024 lds
    buffer_load_dwordx4 v92, s[84:87], s82 offen offset:2048 lds
    buffer_load_dwordx4 v92, s[84:87], s82 offen offset:3072 lds
    s_add_u32 m0, s80, 32768
    s_mov_b32 s82, 16384
    buffer_load_dwordx4 v92, s[84:87], s82 offen offset:0 lds
    buffer_load_dwordx4 v92, s[84:87], s82 offen offset:1024 lds
    buffer_load_dwordx4 v92, s[84:87], s82 offen offset:2048 lds
    buffer_load_dwordx4 v92, s[84:87], s82 offen offset:3072 lds
    s_add_u32 m0, s80, 65536
    s_mov_b32 s82, 32768
    buffer_load_dwordx4 v92, s[84:87], s82 offen offset:0 lds
    buffer_load_dwordx4 v92, s[84:87], s82 offen offset:1024 lds
    buffer_load_dwordx4 v92, s[84:87], s82 offen offset:2048 lds
    buffer_load_dwordx4 v92, s[84:87], s82 offen offset:3072 lds
    s_add_u32 m0, s80, 98304
    s_mov_b32 s82, 49152
    buffer_load_dwordx4 v92, s[84:87], s82 offen offset:0 lds
    buffer_load_dwordx4 v92, s[84:87], s82 offen offset:1024 lds
    buffer_load_dwordx4 v92, s[84:87], s82 offen offset:2048 lds
    buffer_load_dwordx4 v92, s[84:87], s82 offen offset:3072 lds
    s_mul_i32 s28, s32, 4096
    v_add_u32 v4, s28, v8
    s_lshl_b32 s28, s33, 12
    s_add_u32 s28, s28, 16384
    v_add_u32 v5, s28, v8
    s_lshl_b32 s28, s52, 11
    v_add_u32 v5, s28, v5
    v_xor_b32 v13, 0x800, v5
    v_mov_b32 v12, v13
    v_mov_b32 v6, v4
    v_mov_b32 v7, v5
    s_mov_b32 s42, 0
    s_mov_b32 s43, 26
    s_barrier
    buffer_load_dwordx4 v[144:147], v11, s[20:23], 0 offen
    buffer_load_dwordx4 v[148:151], v11, s[20:23], s44 offen
    buffer_load_dwordx4 v[152:155], v11, s[20:23], s45 offen
    buffer_load_dwordx4 v[156:159], v11, s[20:23], s60 offen
    s_add_u32 m0, s35, 0
    s_mov_b32 s46, 0
    buffer_load_dwordx4 v3, s[12:15], s46 offen offset:0 lds
    buffer_load_dwordx4 v3, s[12:15], s46 offen offset:1024 lds
    buffer_load_dwordx4 v3, s[12:15], s46 offen offset:2048 lds
    buffer_load_dwordx4 v3, s[12:15], s46 offen offset:3072 lds
    s_add_u32 m0, s35, 32768
    s_mov_b32 s46, 16384
    buffer_load_dwordx4 v3, s[12:15], s46 offen offset:0 lds
    buffer_load_dwordx4 v3, s[12:15], s46 offen offset:1024 lds
    buffer_load_dwordx4 v3, s[12:15], s46 offen offset:2048 lds
    buffer_load_dwordx4 v3, s[12:15], s46 offen offset:3072 lds
    s_add_u32 m0, s35, 65536
    s_mov_b32 s46, 32768
    buffer_load_dwordx4 v3, s[12:15], s46 offen offset:0 lds
    buffer_load_dwordx4 v3, s[12:15], s46 offen offset:1024 lds
    buffer_load_dwordx4 v3, s[12:15], s46 offen offset:2048 lds
    buffer_load_dwordx4 v3, s[12:15], s46 offen offset:3072 lds
    s_waitcnt vmcnt(32)
    v_lshlrev_b32 v16, 16, v112
    v_mov_b32 v20, v16
    v_mov_b32 v24, 0
    v_mov_b32 v28, 0
    v_and_b32 v17, 0xffff0000, v112
    v_mov_b32 v21, v17
    v_mov_b32 v25, 0
    v_mov_b32 v29, 0
    v_lshlrev_b32 v18, 16, v113
    v_mov_b32 v22, v18
    v_mov_b32 v26, 0
    v_mov_b32 v30, 0
    v_and_b32 v19, 0xffff0000, v113
    v_mov_b32 v23, v19
    v_mov_b32 v27, 0
    v_mov_b32 v31, 0
    v_lshlrev_b32 v32, 16, v114
    v_mov_b32 v36, v32
    v_mov_b32 v40, 0
    v_mov_b32 v44, 0
    v_and_b32 v33, 0xffff0000, v114
    v_mov_b32 v37, v33
    v_mov_b32 v41, 0
    v_mov_b32 v45, 0
    v_lshlrev_b32 v34, 16, v115
    v_mov_b32 v38, v34
    v_mov_b32 v42, 0
    v_mov_b32 v46, 0
    v_and_b32 v35, 0xffff0000, v115
    v_mov_b32 v39, v35
    v_mov_b32 v43, 0
    v_mov_b32 v47, 0
    v_lshlrev_b32 v48, 16, v116
    v_mov_b32 v52, v48
    v_mov_b32 v56, 0
    v_mov_b32 v60, 0
    v_and_b32 v49, 0xffff0000, v116
    v_mov_b32 v53, v49
    v_mov_b32 v57, 0
    v_mov_b32 v61, 0
    v_lshlrev_b32 v50, 16, v117
    v_mov_b32 v54, v50
    v_mov_b32 v58, 0
    v_mov_b32 v62, 0
    v_and_b32 v51, 0xffff0000, v117
    v_mov_b32 v55, v51
    v_mov_b32 v59, 0
    v_mov_b32 v63, 0
    v_lshlrev_b32 v64, 16, v118
    v_mov_b32 v68, v64
    v_mov_b32 v72, 0
    v_mov_b32 v76, 0
    v_and_b32 v65, 0xffff0000, v118
    v_mov_b32 v69, v65
    v_mov_b32 v73, 0
    v_mov_b32 v77, 0
    v_lshlrev_b32 v66, 16, v119
    v_mov_b32 v70, v66
    v_mov_b32 v74, 0
    v_mov_b32 v78, 0
    v_and_b32 v67, 0xffff0000, v119
    v_mov_b32 v71, v67
    v_mov_b32 v75, 0
    v_mov_b32 v79, 0
    s_waitcnt vmcnt(8)
    s_barrier
    ds_read_b128 v[96:99], v6 offset:0
    ds_read_b128 v[80:83], v7 offset:0
    ds_read_b128 v[84:87], v7 offset:1024
    ds_read_b128 v[88:91], v12 offset:0
    ds_read_b128 v[92:95], v12 offset:1024
    ds_read_b128 v[100:103], v6 offset:1024
    ds_read_b128 v[104:107], v6 offset:2048
    ds_read_b128 v[108:111], v6 offset:3072
    s_waitcnt lgkmcnt(0)
    v_mfma_f32_16x16x32_bf16 v[16:19], v[96:99], v[80:83], v[16:19]
    ds_read_b128 v[128:131], v6 offset:8192
    v_mfma_f32_16x16x32_bf16 v[20:23], v[96:99], v[84:87], v[20:23]
    ds_read_b128 v[112:115], v7 offset:8192
    s_add_u32 m0, s36, s35
    v_mfma_f32_16x16x32_bf16 v[24:27], v[96:99], v[88:91], v[24:27]
    ds_read_b128 v[116:119], v7 offset:9216
    buffer_load_dwordx4 v3, s[12:15], s39 offen offset:0 lds
    v_mfma_f32_16x16x32_bf16 v[28:31], v[96:99], v[92:95], v[28:31]
    ds_read_b128 v[120:123], v12 offset:8192
    v_mfma_f32_16x16x32_bf16 v[32:35], v[100:103], v[80:83], v[32:35]
    ds_read_b128 v[124:127], v12 offset:9216
    v_mfma_f32_16x16x32_bf16 v[36:39], v[100:103], v[84:87], v[36:39]
    ds_read_b128 v[132:135], v6 offset:9216
    v_mfma_f32_16x16x32_bf16 v[40:43], v[100:103], v[88:91], v[40:43]
    ds_read_b128 v[136:139], v6 offset:10240
    buffer_load_dwordx4 v3, s[12:15], s39 offen offset:1024 lds
    v_mfma_f32_16x16x32_bf16 v[44:47], v[100:103], v[92:95], v[44:47]
    ds_read_b128 v[140:143], v6 offset:11264
    v_mfma_f32_16x16x32_bf16 v[48:51], v[104:107], v[80:83], v[48:51]
    v_mfma_f32_16x16x32_bf16 v[52:55], v[104:107], v[84:87], v[52:55]
    v_mfma_f32_16x16x32_bf16 v[56:59], v[104:107], v[88:91], v[56:59]
    buffer_load_dwordx4 v3, s[12:15], s39 offen offset:2048 lds
    v_mfma_f32_16x16x32_bf16 v[60:63], v[104:107], v[92:95], v[60:63]
    v_mfma_f32_16x16x32_bf16 v[64:67], v[108:111], v[80:83], v[64:67]
    v_mfma_f32_16x16x32_bf16 v[68:71], v[108:111], v[84:87], v[68:71]
    v_mfma_f32_16x16x32_bf16 v[72:75], v[108:111], v[88:91], v[72:75]
    buffer_load_dwordx4 v3, s[12:15], s39 offen offset:3072 lds
    v_mfma_f32_16x16x32_bf16 v[76:79], v[108:111], v[92:95], v[76:79]
    s_add_u32 s36, s36, 32768
    s_cmp_eq_u32 s36, 131072
    s_cselect_b32 s36, 0, s36
    s_add_u32 s37, s37, 16384
    s_add_u32 s39, s39, 0x4000
    s_add_u32 s42, s42, 32768
    s_cmp_eq_u32 s42, 131072
    s_cselect_b32 s42, 0, s42
    v_add_u32 v6, s42, v4
    v_add_u32 v7, s42, v5
    v_add_u32 v12, s42, v13
    s_waitcnt vmcnt(8) lgkmcnt(0)
    s_barrier
    v_mfma_f32_16x16x32_bf16 v[16:19], v[128:131], v[112:115], v[16:19]
    ds_read_b128 v[96:99], v6 offset:0
    v_mfma_f32_16x16x32_bf16 v[20:23], v[128:131], v[116:119], v[20:23]
    ds_read_b128 v[80:83], v7 offset:0
    s_add_u32 m0, s36, s34
    v_mfma_f32_16x16x32_bf16 v[24:27], v[128:131], v[120:123], v[24:27]
    ds_read_b128 v[84:87], v7 offset:1024
    buffer_load_dwordx4 v2, s[8:11], s37 offen offset:0 lds
    v_mfma_f32_16x16x32_bf16 v[28:31], v[128:131], v[124:127], v[28:31]
    ds_read_b128 v[88:91], v12 offset:0
    v_mfma_f32_16x16x32_bf16 v[32:35], v[132:135], v[112:115], v[32:35]
    ds_read_b128 v[92:95], v12 offset:1024
    v_mfma_f32_16x16x32_bf16 v[36:39], v[132:135], v[116:119], v[36:39]
    ds_read_b128 v[100:103], v6 offset:1024
    v_mfma_f32_16x16x32_bf16 v[40:43], v[132:135], v[120:123], v[40:43]
    ds_read_b128 v[104:107], v6 offset:2048
    buffer_load_dwordx4 v2, s[8:11], s37 offen offset:1024 lds
    v_mfma_f32_16x16x32_bf16 v[44:47], v[132:135], v[124:127], v[44:47]
    ds_read_b128 v[108:111], v6 offset:3072
    v_mfma_f32_16x16x32_bf16 v[48:51], v[136:139], v[112:115], v[48:51]
    v_mfma_f32_16x16x32_bf16 v[52:55], v[136:139], v[116:119], v[52:55]
    v_mfma_f32_16x16x32_bf16 v[56:59], v[136:139], v[120:123], v[56:59]
    buffer_load_dwordx4 v2, s[8:11], s37 offen offset:2048 lds
    v_mfma_f32_16x16x32_bf16 v[60:63], v[136:139], v[124:127], v[60:63]
    v_mfma_f32_16x16x32_bf16 v[64:67], v[140:143], v[112:115], v[64:67]
    v_mfma_f32_16x16x32_bf16 v[68:71], v[140:143], v[116:119], v[68:71]
    v_mfma_f32_16x16x32_bf16 v[72:75], v[140:143], v[120:123], v[72:75]
    buffer_load_dwordx4 v2, s[8:11], s37 offen offset:3072 lds
    v_mfma_f32_16x16x32_bf16 v[76:79], v[140:143], v[124:127], v[76:79]
    s_waitcnt lgkmcnt(0)
    v_mfma_f32_16x16x32_bf16 v[16:19], v[96:99], v[80:83], v[16:19]
    ds_read_b128 v[128:131], v6 offset:8192
    v_mfma_f32_16x16x32_bf16 v[20:23], v[96:99], v[84:87], v[20:23]
    ds_read_b128 v[112:115], v7 offset:8192
    s_add_u32 m0, s36, s35
    v_mfma_f32_16x16x32_bf16 v[24:27], v[96:99], v[88:91], v[24:27]
    ds_read_b128 v[116:119], v7 offset:9216
    buffer_load_dwordx4 v3, s[12:15], s39 offen offset:0 lds
    v_mfma_f32_16x16x32_bf16 v[28:31], v[96:99], v[92:95], v[28:31]
    ds_read_b128 v[120:123], v12 offset:8192
    v_mfma_f32_16x16x32_bf16 v[32:35], v[100:103], v[80:83], v[32:35]
    ds_read_b128 v[124:127], v12 offset:9216
    v_mfma_f32_16x16x32_bf16 v[36:39], v[100:103], v[84:87], v[36:39]
    ds_read_b128 v[132:135], v6 offset:9216
    v_mfma_f32_16x16x32_bf16 v[40:43], v[100:103], v[88:91], v[40:43]
    ds_read_b128 v[136:139], v6 offset:10240
    buffer_load_dwordx4 v3, s[12:15], s39 offen offset:1024 lds
    v_mfma_f32_16x16x32_bf16 v[44:47], v[100:103], v[92:95], v[44:47]
    ds_read_b128 v[140:143], v6 offset:11264
    v_mfma_f32_16x16x32_bf16 v[48:51], v[104:107], v[80:83], v[48:51]
    v_mfma_f32_16x16x32_bf16 v[52:55], v[104:107], v[84:87], v[52:55]
    v_mfma_f32_16x16x32_bf16 v[56:59], v[104:107], v[88:91], v[56:59]
    buffer_load_dwordx4 v3, s[12:15], s39 offen offset:2048 lds
    v_mfma_f32_16x16x32_bf16 v[60:63], v[104:107], v[92:95], v[60:63]
    v_mfma_f32_16x16x32_bf16 v[64:67], v[108:111], v[80:83], v[64:67]
    v_mfma_f32_16x16x32_bf16 v[68:71], v[108:111], v[84:87], v[68:71]
    v_mfma_f32_16x16x32_bf16 v[72:75], v[108:111], v[88:91], v[72:75]
    buffer_load_dwordx4 v3, s[12:15], s39 offen offset:3072 lds
    v_mfma_f32_16x16x32_bf16 v[76:79], v[108:111], v[92:95], v[76:79]
    s_add_u32 s36, s36, 32768
    s_cmp_eq_u32 s36, 131072
    s_cselect_b32 s36, 0, s36
    s_add_u32 s37, s37, 16384
    s_add_u32 s39, s39, 0x4000
    s_add_u32 s42, s42, 32768
    s_cmp_eq_u32 s42, 131072
    s_cselect_b32 s42, 0, s42
    v_add_u32 v6, s42, v4
    v_add_u32 v7, s42, v5
    v_add_u32 v12, s42, v13
    s_waitcnt vmcnt(12) lgkmcnt(0)
    s_barrier
    v_mfma_f32_16x16x32_bf16 v[16:19], v[128:131], v[112:115], v[16:19]
    ds_read_b128 v[96:99], v6 offset:0
    v_mfma_f32_16x16x32_bf16 v[20:23], v[128:131], v[116:119], v[20:23]
    ds_read_b128 v[80:83], v7 offset:0
    s_add_u32 m0, s36, s34
    v_mfma_f32_16x16x32_bf16 v[24:27], v[128:131], v[120:123], v[24:27]
    ds_read_b128 v[84:87], v7 offset:1024
    buffer_load_dwordx4 v2, s[8:11], s37 offen offset:0 lds
    v_mfma_f32_16x16x32_bf16 v[28:31], v[128:131], v[124:127], v[28:31]
    ds_read_b128 v[88:91], v12 offset:0
    v_mfma_f32_16x16x32_bf16 v[32:35], v[132:135], v[112:115], v[32:35]
    ds_read_b128 v[92:95], v12 offset:1024
    v_mfma_f32_16x16x32_bf16 v[36:39], v[132:135], v[116:119], v[36:39]
    ds_read_b128 v[100:103], v6 offset:1024
    v_mfma_f32_16x16x32_bf16 v[40:43], v[132:135], v[120:123], v[40:43]
    ds_read_b128 v[104:107], v6 offset:2048
    buffer_load_dwordx4 v2, s[8:11], s37 offen offset:1024 lds
    v_mfma_f32_16x16x32_bf16 v[44:47], v[132:135], v[124:127], v[44:47]
    ds_read_b128 v[108:111], v6 offset:3072
    v_mfma_f32_16x16x32_bf16 v[48:51], v[136:139], v[112:115], v[48:51]
    v_mfma_f32_16x16x32_bf16 v[52:55], v[136:139], v[116:119], v[52:55]
    v_mfma_f32_16x16x32_bf16 v[56:59], v[136:139], v[120:123], v[56:59]
    buffer_load_dwordx4 v2, s[8:11], s37 offen offset:2048 lds
    v_mfma_f32_16x16x32_bf16 v[60:63], v[136:139], v[124:127], v[60:63]
    v_mfma_f32_16x16x32_bf16 v[64:67], v[140:143], v[112:115], v[64:67]
    v_mfma_f32_16x16x32_bf16 v[68:71], v[140:143], v[116:119], v[68:71]
    v_mfma_f32_16x16x32_bf16 v[72:75], v[140:143], v[120:123], v[72:75]
    buffer_load_dwordx4 v2, s[8:11], s37 offen offset:3072 lds
    v_mfma_f32_16x16x32_bf16 v[76:79], v[140:143], v[124:127], v[76:79]
.p2align 3
Lg2b_loop:
    s_waitcnt lgkmcnt(0)
    s_nop 0
    v_mfma_f32_16x16x32_bf16 v[16:19], v[96:99], v[80:83], v[16:19]
    ds_read_b128 v[128:131], v6 offset:8192
    v_mfma_f32_16x16x32_bf16 v[20:23], v[96:99], v[84:87], v[20:23]
    ds_read_b128 v[112:115], v7 offset:8192
    s_add_u32 m0, s36, s35
    s_nop 0
    v_mfma_f32_16x16x32_bf16 v[24:27], v[96:99], v[88:91], v[24:27]
    ds_read_b128 v[116:119], v7 offset:9216
    buffer_load_dwordx4 v3, s[12:15], s39 offen offset:0 lds
    v_mfma_f32_16x16x32_bf16 v[28:31], v[96:99], v[92:95], v[28:31]
    ds_read_b128 v[120:123], v12 offset:8192
    v_mfma_f32_16x16x32_bf16 v[32:35], v[100:103], v[80:83], v[32:35]
    ds_read_b128 v[124:127], v12 offset:9216
    v_mfma_f32_16x16x32_bf16 v[36:39], v[100:103], v[84:87], v[36:39]
    ds_read_b128 v[132:135], v6 offset:9216
    v_mfma_f32_16x16x32_bf16 v[40:43], v[100:103], v[88:91], v[40:43]
    ds_read_b128 v[136:139], v6 offset:10240
    buffer_load_dwordx4 v3, s[12:15], s39 offen offset:1024 lds
    v_mfma_f32_16x16x32_bf16 v[44:47], v[100:103], v[92:95], v[44:47]
    ds_read_b128 v[140:143], v6 offset:11264
    v_mfma_f32_16x16x32_bf16 v[48:51], v[104:107], v[80:83], v[48:51]
    v_mfma_f32_16x16x32_bf16 v[52:55], v[104:107], v[84:87], v[52:55]
    v_mfma_f32_16x16x32_bf16 v[56:59], v[104:107], v[88:91], v[56:59]
    buffer_load_dwordx4 v3, s[12:15], s39 offen offset:2048 lds
    v_mfma_f32_16x16x32_bf16 v[60:63], v[104:107], v[92:95], v[60:63]
    v_mfma_f32_16x16x32_bf16 v[64:67], v[108:111], v[80:83], v[64:67]
    v_mfma_f32_16x16x32_bf16 v[68:71], v[108:111], v[84:87], v[68:71]
    v_mfma_f32_16x16x32_bf16 v[72:75], v[108:111], v[88:91], v[72:75]
    buffer_load_dwordx4 v3, s[12:15], s39 offen offset:3072 lds
    v_mfma_f32_16x16x32_bf16 v[76:79], v[108:111], v[92:95], v[76:79]
    s_add_u32 s36, s36, 32768
    s_cmp_eq_u32 s36, 131072
    s_cselect_b32 s36, 0, s36
    s_nop 0
    s_add_u32 s37, s37, 16384
    s_add_u32 s39, s39, 0x4000
    s_add_u32 s42, s42, 32768
    s_cmp_eq_u32 s42, 131072
    s_cselect_b32 s42, 0, s42
    v_add_u32 v6, s42, v4
    v_add_u32 v7, s42, v5
    v_add_u32 v12, s42, v13
    s_waitcnt vmcnt(16) lgkmcnt(0)
    s_barrier
    v_mfma_f32_16x16x32_bf16 v[16:19], v[128:131], v[112:115], v[16:19]
    ds_read_b128 v[96:99], v6 offset:0
    v_mfma_f32_16x16x32_bf16 v[20:23], v[128:131], v[116:119], v[20:23]
    ds_read_b128 v[80:83], v7 offset:0
    s_add_u32 m0, s36, s34
    s_nop 0
    v_mfma_f32_16x16x32_bf16 v[24:27], v[128:131], v[120:123], v[24:27]
    ds_read_b128 v[84:87], v7 offset:1024
    buffer_load_dwordx4 v2, s[8:11], s37 offen offset:0 lds
    v_mfma_f32_16x16x32_bf16 v[28:31], v[128:131], v[124:127], v[28:31]
    ds_read_b128 v[88:91], v12 offset:0
    v_mfma_f32_16x16x32_bf16 v[32:35], v[132:135], v[112:115], v[32:35]
    ds_read_b128 v[92:95], v12 offset:1024
    v_mfma_f32_16x16x32_bf16 v[36:39], v[132:135], v[116:119], v[36:39]
    ds_read_b128 v[100:103], v6 offset:1024
    v_mfma_f32_16x16x32_bf16 v[40:43], v[132:135], v[120:123], v[40:43]
    ds_read_b128 v[104:107], v6 offset:2048
    buffer_load_dwordx4 v2, s[8:11], s37 offen offset:1024 lds
    v_mfma_f32_16x16x32_bf16 v[44:47], v[132:135], v[124:127], v[44:47]
    ds_read_b128 v[108:111], v6 offset:3072
    v_mfma_f32_16x16x32_bf16 v[48:51], v[136:139], v[112:115], v[48:51]
    v_mfma_f32_16x16x32_bf16 v[52:55], v[136:139], v[116:119], v[52:55]
    v_mfma_f32_16x16x32_bf16 v[56:59], v[136:139], v[120:123], v[56:59]
    buffer_load_dwordx4 v2, s[8:11], s37 offen offset:2048 lds
    v_mfma_f32_16x16x32_bf16 v[60:63], v[136:139], v[124:127], v[60:63]
    v_mfma_f32_16x16x32_bf16 v[64:67], v[140:143], v[112:115], v[64:67]
    v_mfma_f32_16x16x32_bf16 v[68:71], v[140:143], v[116:119], v[68:71]
    v_mfma_f32_16x16x32_bf16 v[72:75], v[140:143], v[120:123], v[72:75]
    buffer_load_dwordx4 v2, s[8:11], s37 offen offset:3072 lds
    v_mfma_f32_16x16x32_bf16 v[76:79], v[140:143], v[124:127], v[76:79]
    s_sub_u32 s43, s43, 1
    s_cmp_lg_u32 s43, 0
    s_cbranch_scc1 Lg2b_loop
    s_waitcnt vmcnt(0) lgkmcnt(0)
    s_lshl_b32 s28, s2, 2
    s_add_u32 s28, s28, s3
    s_xor_b32 s29, s28, 4
    s_add_u32 s8, s6, 92274688
    s_addc_u32 s9, s7, 0
    s_and_b32 s9, s9, 0xffff
    s_mov_b32 s10, 8388608
    s_mov_b32 s11, 0x20000
    s_add_u32 s12, s6, 58720256
    s_addc_u32 s13, s7, 0
    s_and_b32 s13, s13, 0xffff
    s_mov_b32 s14, 262144
    s_mov_b32 s15, 0x20000
    s_lshl_b32 s54, s28, 13
    s_add_u32 s55, s54, 0x1000
    s_lshl_b32 s56, s29, 13
    s_add_u32 s57, s56, 0x1000
    s_lshl_b32 s28, s2, 3
    s_add_u32 s28, s28, s3
    s_lshl_b32 s28, s28, 7
    s_xor_b32 s29, s28, 0x400
    v_cvt_pk_bf16_f32 v80, v24, v25
    v_cvt_pk_bf16_f32 v81, v26, v27
    v_cvt_pk_bf16_f32 v82, v40, v41
    v_cvt_pk_bf16_f32 v83, v42, v43
    buffer_store_dwordx4 v[80:83], v8, s[8:11], s54 offen offset:0 sc1
    v_cvt_pk_bf16_f32 v84, v56, v57
    v_cvt_pk_bf16_f32 v85, v58, v59
    v_cvt_pk_bf16_f32 v86, v72, v73
    v_cvt_pk_bf16_f32 v87, v74, v75
    buffer_store_dwordx4 v[84:87], v8, s[8:11], s54 offen offset:1024 sc1
    v_cvt_pk_bf16_f32 v88, v28, v29
    v_cvt_pk_bf16_f32 v89, v30, v31
    v_cvt_pk_bf16_f32 v90, v44, v45
    v_cvt_pk_bf16_f32 v91, v46, v47
    buffer_store_dwordx4 v[88:91], v8, s[8:11], s54 offen offset:2048 sc1
    v_cvt_pk_bf16_f32 v92, v60, v61
    v_cvt_pk_bf16_f32 v93, v62, v63
    v_cvt_pk_bf16_f32 v94, v76, v77
    v_cvt_pk_bf16_f32 v95, v78, v79
    buffer_store_dwordx4 v[92:95], v8, s[8:11], s54 offen offset:3072 sc1
    s_add_u32 s16, s40, s53
    s_addc_u32 s17, s41, 0
    s_and_b32 s17, s17, 0xffff
    s_mov_b32 s18, s47
    s_mov_b32 s19, 0x20000
    v_mov_b32 v2, 2
    v_mov_b32 v3, 0
    s_mov_b32 s58, 0x40000
    s_waitcnt vmcnt(0)
    s_mov_b64 exec, 1
    buffer_store_dword v2, v3, s[12:15], s28 offen sc1
Lg2b_poll:
    buffer_load_dword v4, v3, s[12:15], s29 offen sc1
    s_sub_u32 s58, s58, 1
    s_waitcnt vmcnt(0)
    v_readfirstlane_b32 s59, v4
    s_cmp_eq_u32 s58, 0
    s_cbranch_scc1 Lg2b_go
    s_cmp_eq_u32 s59, 2
    s_cbranch_scc0 Lg2b_poll
Lg2b_go:
    s_mov_b64 exec, -1
    buffer_load_dwordx4 v[96:99], v8, s[8:11], s56 offen offset:0 sc1
    buffer_load_dwordx4 v[100:103], v8, s[8:11], s56 offen offset:1024 sc1
    buffer_load_dwordx4 v[104:107], v8, s[8:11], s56 offen offset:2048 sc1
    buffer_load_dwordx4 v[108:111], v8, s[8:11], s56 offen offset:3072 sc1
    s_waitcnt vmcnt(3)
    v_lshlrev_b32 v24, 16, v96
    v_and_b32 v25, 0xffff0000, v96
    v_lshlrev_b32 v26, 16, v97
    v_and_b32 v27, 0xffff0000, v97
    v_lshlrev_b32 v40, 16, v98
    v_and_b32 v41, 0xffff0000, v98
    v_lshlrev_b32 v42, 16, v99
    v_and_b32 v43, 0xffff0000, v99
    v_pk_add_f32 v[16:17], v[16:17], v[24:25]
    v_pk_add_f32 v[18:19], v[18:19], v[26:27]
    v_pk_add_f32 v[32:33], v[32:33], v[40:41]
    v_pk_add_f32 v[34:35], v[34:35], v[42:43]
    v_cvt_pk_bf16_f32 v112, v16, v17
    v_cvt_pk_bf16_f32 v113, v18, v19
    v_cvt_pk_bf16_f32 v114, v32, v33
    v_cvt_pk_bf16_f32 v115, v34, v35
    ds_write_b128 v14, v[112:115] offset:0
    s_waitcnt vmcnt(2)
    v_lshlrev_b32 v56, 16, v100
    v_and_b32 v57, 0xffff0000, v100
    v_lshlrev_b32 v58, 16, v101
    v_and_b32 v59, 0xffff0000, v101
    v_lshlrev_b32 v72, 16, v102
    v_and_b32 v73, 0xffff0000, v102
    v_lshlrev_b32 v74, 16, v103
    v_and_b32 v75, 0xffff0000, v103
    v_pk_add_f32 v[48:49], v[48:49], v[56:57]
    v_pk_add_f32 v[50:51], v[50:51], v[58:59]
    v_pk_add_f32 v[64:65], v[64:65], v[72:73]
    v_pk_add_f32 v[66:67], v[66:67], v[74:75]
    v_cvt_pk_bf16_f32 v116, v48, v49
    v_cvt_pk_bf16_f32 v117, v50, v51
    v_cvt_pk_bf16_f32 v118, v64, v65
    v_cvt_pk_bf16_f32 v119, v66, v67
    ds_write_b128 v14, v[116:119] offset:64
    s_waitcnt vmcnt(1)
    v_lshlrev_b32 v24, 16, v104
    v_and_b32 v25, 0xffff0000, v104
    v_lshlrev_b32 v26, 16, v105
    v_and_b32 v27, 0xffff0000, v105
    v_lshlrev_b32 v40, 16, v106
    v_and_b32 v41, 0xffff0000, v106
    v_lshlrev_b32 v42, 16, v107
    v_and_b32 v43, 0xffff0000, v107
    v_pk_add_f32 v[20:21], v[20:21], v[24:25]
    v_pk_add_f32 v[22:23], v[22:23], v[26:27]
    v_pk_add_f32 v[36:37], v[36:37], v[40:41]
    v_pk_add_f32 v[38:39], v[38:39], v[42:43]
    v_cvt_pk_bf16_f32 v120, v20, v21
    v_cvt_pk_bf16_f32 v121, v22, v23
    v_cvt_pk_bf16_f32 v122, v36, v37
    v_cvt_pk_bf16_f32 v123, v38, v39
    ds_write_b128 v14, v[120:123] offset:2304
    s_waitcnt vmcnt(0)
    v_lshlrev_b32 v56, 16, v108
    v_and_b32 v57, 0xffff0000, v108
    v_lshlrev_b32 v58, 16, v109
    v_and_b32 v59, 0xffff0000, v109
    v_lshlrev_b32 v72, 16, v110
    v_and_b32 v73, 0xffff0000, v110
    v_lshlrev_b32 v74, 16, v111
    v_and_b32 v75, 0xffff0000, v111
    v_pk_add_f32 v[52:53], v[52:53], v[56:57]
    v_pk_add_f32 v[54:55], v[54:55], v[58:59]
    v_pk_add_f32 v[68:69], v[68:69], v[72:73]
    v_pk_add_f32 v[70:71], v[70:71], v[74:75]
    v_cvt_pk_bf16_f32 v124, v52, v53
    v_cvt_pk_bf16_f32 v125, v54, v55
    v_cvt_pk_bf16_f32 v126, v68, v69
    v_cvt_pk_bf16_f32 v127, v70, v71
    ds_write_b128 v14, v[124:127] offset:2368
    s_waitcnt lgkmcnt(0)
    ds_read_b128 v[112:115], v15 offset:0
    ds_read_b128 v[116:119], v15 offset:1152
    ds_read_b128 v[120:123], v15 offset:2304
    ds_read_b128 v[124:127], v15 offset:3456
    v_lshlrev_b32 v80, 16, v144
    v_and_b32 v81, 0xffff0000, v144
    v_lshlrev_b32 v82, 16, v145
    v_and_b32 v83, 0xffff0000, v145
    v_lshlrev_b32 v84, 16, v146
    v_and_b32 v85, 0xffff0000, v146
    v_lshlrev_b32 v86, 16, v147
    v_and_b32 v87, 0xffff0000, v147
    s_waitcnt lgkmcnt(3)
    v_lshlrev_b32 v96, 16, v112
    v_and_b32 v97, 0xffff0000, v112
    v_lshlrev_b32 v98, 16, v113
    v_and_b32 v99, 0xffff0000, v113
    v_lshlrev_b32 v100, 16, v114
    v_and_b32 v101, 0xffff0000, v114
    v_lshlrev_b32 v102, 16, v115
    v_and_b32 v103, 0xffff0000, v115
    v_pk_add_f32 v[80:81], v[80:81], v[96:97]
    v_pk_add_f32 v[82:83], v[82:83], v[98:99]
    v_pk_add_f32 v[84:85], v[84:85], v[100:101]
    v_pk_add_f32 v[86:87], v[86:87], v[102:103]
    v_cvt_pk_bf16_f32 v112, v80, v81
    v_cvt_pk_bf16_f32 v113, v82, v83
    v_cvt_pk_bf16_f32 v114, v84, v85
    v_cvt_pk_bf16_f32 v115, v86, v87
    buffer_store_dwordx4 v[112:115], v11, s[16:19], 0 offen
    v_lshlrev_b32 v88, 16, v148
    v_and_b32 v89, 0xffff0000, v148
    v_lshlrev_b32 v90, 16, v149
    v_and_b32 v91, 0xffff0000, v149
    v_lshlrev_b32 v92, 16, v150
    v_and_b32 v93, 0xffff0000, v150
    v_lshlrev_b32 v94, 16, v151
    v_and_b32 v95, 0xffff0000, v151
    s_waitcnt lgkmcnt(2)
    v_lshlrev_b32 v104, 16, v116
    v_and_b32 v105, 0xffff0000, v116
    v_lshlrev_b32 v106, 16, v117
    v_and_b32 v107, 0xffff0000, v117
    v_lshlrev_b32 v108, 16, v118
    v_and_b32 v109, 0xffff0000, v118
    v_lshlrev_b32 v110, 16, v119
    v_and_b32 v111, 0xffff0000, v119
    v_pk_add_f32 v[88:89], v[88:89], v[104:105]
    v_pk_add_f32 v[90:91], v[90:91], v[106:107]
    v_pk_add_f32 v[92:93], v[92:93], v[108:109]
    v_pk_add_f32 v[94:95], v[94:95], v[110:111]
    v_cvt_pk_bf16_f32 v116, v88, v89
    v_cvt_pk_bf16_f32 v117, v90, v91
    v_cvt_pk_bf16_f32 v118, v92, v93
    v_cvt_pk_bf16_f32 v119, v94, v95
    buffer_store_dwordx4 v[116:119], v11, s[16:19], s44 offen
    v_lshlrev_b32 v80, 16, v152
    v_and_b32 v81, 0xffff0000, v152
    v_lshlrev_b32 v82, 16, v153
    v_and_b32 v83, 0xffff0000, v153
    v_lshlrev_b32 v84, 16, v154
    v_and_b32 v85, 0xffff0000, v154
    v_lshlrev_b32 v86, 16, v155
    v_and_b32 v87, 0xffff0000, v155
    s_waitcnt lgkmcnt(1)
    v_lshlrev_b32 v96, 16, v120
    v_and_b32 v97, 0xffff0000, v120
    v_lshlrev_b32 v98, 16, v121
    v_and_b32 v99, 0xffff0000, v121
    v_lshlrev_b32 v100, 16, v122
    v_and_b32 v101, 0xffff0000, v122
    v_lshlrev_b32 v102, 16, v123
    v_and_b32 v103, 0xffff0000, v123
    v_pk_add_f32 v[80:81], v[80:81], v[96:97]
    v_pk_add_f32 v[82:83], v[82:83], v[98:99]
    v_pk_add_f32 v[84:85], v[84:85], v[100:101]
    v_pk_add_f32 v[86:87], v[86:87], v[102:103]
    v_cvt_pk_bf16_f32 v120, v80, v81
    v_cvt_pk_bf16_f32 v121, v82, v83
    v_cvt_pk_bf16_f32 v122, v84, v85
    v_cvt_pk_bf16_f32 v123, v86, v87
    buffer_store_dwordx4 v[120:123], v11, s[16:19], s45 offen
    v_lshlrev_b32 v88, 16, v156
    v_and_b32 v89, 0xffff0000, v156
    v_lshlrev_b32 v90, 16, v157
    v_and_b32 v91, 0xffff0000, v157
    v_lshlrev_b32 v92, 16, v158
    v_and_b32 v93, 0xffff0000, v158
    v_lshlrev_b32 v94, 16, v159
    v_and_b32 v95, 0xffff0000, v159
    s_waitcnt lgkmcnt(0)
    v_lshlrev_b32 v104, 16, v124
    v_and_b32 v105, 0xffff0000, v124
    v_lshlrev_b32 v106, 16, v125
    v_and_b32 v107, 0xffff0000, v125
    v_lshlrev_b32 v108, 16, v126
    v_and_b32 v109, 0xffff0000, v126
    v_lshlrev_b32 v110, 16, v127
    v_and_b32 v111, 0xffff0000, v127
    v_pk_add_f32 v[88:89], v[88:89], v[104:105]
    v_pk_add_f32 v[90:91], v[90:91], v[106:107]
    v_pk_add_f32 v[92:93], v[92:93], v[108:109]
    v_pk_add_f32 v[94:95], v[94:95], v[110:111]
    v_cvt_pk_bf16_f32 v124, v88, v89
    v_cvt_pk_bf16_f32 v125, v90, v91
    v_cvt_pk_bf16_f32 v126, v92, v93
    v_cvt_pk_bf16_f32 v127, v94, v95
    buffer_store_dwordx4 v[124:127], v11, s[16:19], s60 offen
Lm_end:
    s_endpgm
Lf_help:
    s_lshl_b32 s4, s2, 2
    s_add_u32 s4, s4, s3
    s_sub_u32 s4, s4, 4
    s_cmp_lg_u32 s4, 0
    s_cbranch_scc1 Lf_n0
    s_load_dwordx2 s[64:65], s[0:1], 96
    s_memrealtime s[72:73]
    v_mov_b32 v82, 0
    s_waitcnt lgkmcnt(0)
    s_and_b32 s65, s65, 0xffff
    s_mov_b32 s66, 8
    s_mov_b32 s67, 0x20000
    v_mov_b32 v86, s72
    v_mov_b32 v87, s73
    s_mov_b64 exec, 1
    buffer_store_dwordx2 v[86:87], v82, s[64:67], 0 offen sc1
    s_mov_b64 exec, -1
Lf_n0:
    s_barrier
    s_cmp_ge_u32 s4, 896
    s_cbranch_scc1 Lf_idle
    s_barrier
    s_cmp_lg_u32 s3, 4
    s_cbranch_scc1 Lf_nh
    s_load_dwordx2 s[64:65], s[0:1], 96
    v_mov_b32 v82, 0
    s_waitcnt lgkmcnt(0)
    s_and_b32 s65, s65, 0xffff
    s_mov_b32 s66, 8
    s_mov_b32 s67, 0x20000
    s_mov_b32 s58, 0x40000
    buffer_load_dwordx2 v[86:87], v82, s[64:67], 0 offen sc1
Lh_np:
    s_waitcnt vmcnt(0)
    v_readfirstlane_b32 s72, v86
    v_readfirstlane_b32 s73, v87
    s_nop 3
    s_cmp_lg_u64 s[72:73], 0
    s_cbranch_scc1 Lh_ng
    s_sub_u32 s58, s58, 1
    s_cbranch_scc1 Lh_ng
    buffer_load_dwordx2 v[86:87], v82, s[64:67], 0 offen sc1
    s_branch Lh_np
Lh_ng:
Lf_nh:
    s_load_dwordx2 s[8:9], s[0:1], 56
    v_lshrrev_b32 v2, 4, v1
    v_and_b32 v3, 15, v1
    s_sub_u32 s26, s3, 4
    s_lshl_b32 s26, s26, 13
    s_add_u32 s26, s26, 103680
    s_mul_i32 s5, s4, 2341
    s_lshr_b32 s5, s5, 16
    s_mul_i32 s20, s5, 28
    s_sub_u32 s20, s4, s20
    s_mul_i32 s21, s5, 229376
    s_lshl_b32 s22, s20, 8
    s_add_u32 s21, s21, s22
    v_mul_u32_u24 v4, 57344, v2
    v_lshl_add_u32 v4, v3, 4, v4
    s_waitcnt lgkmcnt(0)
    s_mov_b32 s12, s8
    s_and_b32 s13, s9, 0xffff
    s_mov_b32 s14, 7340032
    s_mov_b32 s15, 0x20000
    buffer_load_dwordx4 v[16:19], v4, s[12:15], s21 offen
    s_add_u32 s21, s21, 7168
    buffer_load_dwordx4 v[20:23], v4, s[12:15], s21 offen
    s_add_u32 s21, s21, 7168
    buffer_load_dwordx4 v[24:27], v4, s[12:15], s21 offen
    s_add_u32 s21, s21, 7168
    buffer_load_dwordx4 v[28:31], v4, s[12:15], s21 offen
    s_add_u32 s21, s21, 7168
    buffer_load_dwordx4 v[32:35], v4, s[12:15], s21 offen
    s_add_u32 s21, s21, 7168
    buffer_load_dwordx4 v[36:39], v4, s[12:15], s21 offen
    s_add_u32 s21, s21, 7168
    buffer_load_dwordx4 v[40:43], v4, s[12:15], s21 offen
    s_add_u32 s21, s21, 7168
    buffer_load_dwordx4 v[44:47], v4, s[12:15], s21 offen
    s_barrier
    s_barrier
    v_lshrrev_b32 v2, 4, v1
    v_and_b32 v3, 15, v1
    s_sub_u32 s26, s3, 4
    s_lshl_b32 s26, s26, 13
    s_add_u32 s26, s26, 103680
    s_mul_i32 s5, s4, 2341
    s_lshr_b32 s5, s5, 16
    s_mul_i32 s20, s5, 28
    s_sub_u32 s20, s4, s20
    s_mul_i32 s21, s5, 229376
    s_lshl_b32 s22, s20, 8
    s_add_u32 s21, s21, s22
    v_mul_u32_u24 v4, 57344, v2
    v_lshl_add_u32 v4, v3, 4, v4
    s_add_u32 s16, s6, 0
    s_addc_u32 s17, s7, 0
    s_and_b32 s17, s17, 0xffff
    s_mov_b32 s18, 7340032
    s_mov_b32 s19, 0x20000
    v_lshrrev_b32 v5, 1, v3
    v_lshlrev_b32 v5, 10, v5
    v_and_b32 v6, 1, v3
    v_lshl_add_u32 v5, v6, 7, v5
    v_lshl_add_u32 v5, v2, 8, v5
    v_and_b32 v6, 7, v3
    v_lshl_add_u32 v5, v6, 4, v5
    v_add_u32 v5, s26, v5
    v_bfe_u32 v6, v1, 3, 1
    v_xor_b32 v6, v6, v1
    v_lshlrev_b32 v6, 4, v6
    v_add_u32 v8, s26, v6
    v_xor_b32 v9, 32, v8
    v_xor_b32 v10, 64, v8
    v_xor_b32 v11, 96, v8
    v_lshlrev_b32 v7, 4, v1
    s_lshl_b32 s20, s20, 3
    s_add_u32 s22, s20, 0
    s_mul_i32 s23, s22, 4682
    s_lshr_b32 s23, s23, 16
    s_mul_i32 s27, s23, 14
    s_sub_u32 s22, s22, s27
    s_sub_u32 s27, s22, 1
    s_cmp_gt_u32 s22, 7
    s_cselect_b32 s27, s27, s22
    s_cmp_eq_u32 s22, 7
    s_cselect_b32 s27, 13, s27
    s_lshl_b32 s23, s23, 5
    s_add_u32 s23, s23, s5
    s_mul_i32 s23, s23, 14
    s_add_u32 s23, s23, s27
    s_lshl_b32 s28, s23, 10
    s_add_u32 s22, s20, 1
    s_mul_i32 s23, s22, 4682
    s_lshr_b32 s23, s23, 16
    s_mul_i32 s27, s23, 14
    s_sub_u32 s22, s22, s27
    s_sub_u32 s27, s22, 1
    s_cmp_gt_u32 s22, 7
    s_cselect_b32 s27, s27, s22
    s_cmp_eq_u32 s22, 7
    s_cselect_b32 s27, 13, s27
    s_lshl_b32 s23, s23, 5
    s_add_u32 s23, s23, s5
    s_mul_i32 s23, s23, 14
    s_add_u32 s23, s23, s27
    s_lshl_b32 s29, s23, 10
    s_add_u32 s22, s20, 2
    s_mul_i32 s23, s22, 4682
    s_lshr_b32 s23, s23, 16
    s_mul_i32 s27, s23, 14
    s_sub_u32 s22, s22, s27
    s_sub_u32 s27, s22, 1
    s_cmp_gt_u32 s22, 7
    s_cselect_b32 s27, s27, s22
    s_cmp_eq_u32 s22, 7
    s_cselect_b32 s27, 13, s27
    s_lshl_b32 s23, s23, 5
    s_add_u32 s23, s23, s5
    s_mul_i32 s23, s23, 14
    s_add_u32 s23, s23, s27
    s_lshl_b32 s30, s23, 10
    s_add_u32 s22, s20, 3
    s_mul_i32 s23, s22, 4682
    s_lshr_b32 s23, s23, 16
    s_mul_i32 s27, s23, 14
    s_sub_u32 s22, s22, s27
    s_sub_u32 s27, s22, 1
    s_cmp_gt_u32 s22, 7
    s_cselect_b32 s27, s27, s22
    s_cmp_eq_u32 s22, 7
    s_cselect_b32 s27, 13, s27
    s_lshl_b32 s23, s23, 5
    s_add_u32 s23, s23, s5
    s_mul_i32 s23, s23, 14
    s_add_u32 s23, s23, s27
    s_lshl_b32 s31, s23, 10
    s_add_u32 s22, s20, 4
    s_mul_i32 s23, s22, 4682
    s_lshr_b32 s23, s23, 16
    s_mul_i32 s27, s23, 14
    s_sub_u32 s22, s22, s27
    s_sub_u32 s27, s22, 1
    s_cmp_gt_u32 s22, 7
    s_cselect_b32 s27, s27, s22
    s_cmp_eq_u32 s22, 7
    s_cselect_b32 s27, 13, s27
    s_lshl_b32 s23, s23, 5
    s_add_u32 s23, s23, s5
    s_mul_i32 s23, s23, 14
    s_add_u32 s23, s23, s27
    s_lshl_b32 s32, s23, 10
    s_add_u32 s22, s20, 5
    s_mul_i32 s23, s22, 4682
    s_lshr_b32 s23, s23, 16
    s_mul_i32 s27, s23, 14
    s_sub_u32 s22, s22, s27
    s_sub_u32 s27, s22, 1
    s_cmp_gt_u32 s22, 7
    s_cselect_b32 s27, s27, s22
    s_cmp_eq_u32 s22, 7
    s_cselect_b32 s27, 13, s27
    s_lshl_b32 s23, s23, 5
    s_add_u32 s23, s23, s5
    s_mul_i32 s23, s23, 14
    s_add_u32 s23, s23, s27
    s_lshl_b32 s33, s23, 10
    s_add_u32 s22, s20, 6
    s_mul_i32 s23, s22, 4682
    s_lshr_b32 s23, s23, 16
    s_mul_i32 s27, s23, 14
    s_sub_u32 s22, s22, s27
    s_sub_u32 s27, s22, 1
    s_cmp_gt_u32 s22, 7
    s_cselect_b32 s27, s27, s22
    s_cmp_eq_u32 s22, 7
    s_cselect_b32 s27, 13, s27
    s_lshl_b32 s23, s23, 5
    s_add_u32 s23, s23, s5
    s_mul_i32 s23, s23, 14
    s_add_u32 s23, s23, s27
    s_lshl_b32 s34, s23, 10
    s_add_u32 s22, s20, 7
    s_mul_i32 s23, s22, 4682
    s_lshr_b32 s23, s23, 16
    s_mul_i32 s27, s23, 14
    s_sub_u32 s22, s22, s27
    s_sub_u32 s27, s22, 1
    s_cmp_gt_u32 s22, 7
    s_cselect_b32 s27, s27, s22
    s_cmp_eq_u32 s22, 7
    s_cselect_b32 s27, 13, s27
    s_lshl_b32 s23, s23, 5
    s_add_u32 s23, s23, s5
    s_mul_i32 s23, s23, 14
    s_add_u32 s23, s23, s27
    s_lshl_b32 s35, s23, 10
    s_mov_b32 s24, 0x05040100
    s_mov_b32 s25, 0x07060302
    s_waitcnt vmcnt(0)
    v_perm_b32 v48, v20, v16, s24
    v_perm_b32 v49, v28, v24, s24
    v_perm_b32 v50, v36, v32, s24
    v_perm_b32 v51, v44, v40, s24
    v_xor_b32 v12, 0, v5
    ds_write_b128 v12, v[48:51] offset:0
    v_perm_b32 v52, v20, v16, s25
    v_perm_b32 v53, v28, v24, s25
    v_perm_b32 v54, v36, v32, s25
    v_perm_b32 v55, v44, v40, s25
    v_xor_b32 v13, 16, v5
    ds_write_b128 v13, v[52:55] offset:0
    v_perm_b32 v56, v21, v17, s24
    v_perm_b32 v57, v29, v25, s24
    v_perm_b32 v58, v37, v33, s24
    v_perm_b32 v59, v45, v41, s24
    v_xor_b32 v12, 32, v5
    ds_write_b128 v12, v[56:59] offset:0
    v_perm_b32 v60, v21, v17, s25
    v_perm_b32 v61, v29, v25, s25
    v_perm_b32 v62, v37, v33, s25
    v_perm_b32 v63, v45, v41, s25
    v_xor_b32 v13, 48, v5
    ds_write_b128 v13, v[60:63] offset:0
    v_perm_b32 v64, v22, v18, s24
    v_perm_b32 v65, v30, v26, s24
    v_perm_b32 v66, v38, v34, s24
    v_perm_b32 v67, v46, v42, s24
    v_xor_b32 v12, 64, v5
    ds_write_b128 v12, v[64:67] offset:0
    v_perm_b32 v68, v22, v18, s25
    v_perm_b32 v69, v30, v26, s25
    v_perm_b32 v70, v38, v34, s25
    v_perm_b32 v71, v46, v42, s25
    v_xor_b32 v13, 80, v5
    ds_write_b128 v13, v[68:71] offset:0
    v_perm_b32 v72, v23, v19, s24
    v_perm_b32 v73, v31, v27, s24
    v_perm_b32 v74, v39, v35, s24
    v_perm_b32 v75, v47, v43, s24
    v_xor_b32 v12, 96, v5
    ds_write_b128 v12, v[72:75] offset:0
    v_perm_b32 v76, v23, v19, s25
    v_perm_b32 v77, v31, v27, s25
    v_perm_b32 v78, v39, v35, s25
    v_perm_b32 v79, v47, v43, s25
    v_xor_b32 v13, 112, v5
    ds_write_b128 v13, v[76:79] offset:0
    s_waitcnt lgkmcnt(0)
    ds_read_b128 v[16:19], v8 offset:0
    ds_read_b128 v[20:23], v9 offset:1024
    ds_read_b128 v[24:27], v10 offset:2048
    ds_read_b128 v[28:31], v11 offset:3072
    ds_read_b128 v[32:35], v8 offset:4096
    ds_read_b128 v[36:39], v9 offset:5120
    ds_read_b128 v[40:43], v10 offset:6144
    ds_read_b128 v[44:47], v11 offset:7168
    s_load_dwordx2 s[8:9], s[0:1], 72
    v_lshrrev_b32 v2, 4, v1
    v_and_b32 v3, 15, v1
    s_sub_u32 s26, s3, 4
    s_lshl_b32 s26, s26, 12
    s_add_u32 s26, s26, 135168
    s_lshr_b32 s5, s4, 3
    s_and_b32 s20, s4, 7
    s_lshl_b32 s21, s5, 16
    s_lshl_b32 s22, s20, 8
    s_add_u32 s21, s21, s22
    v_lshlrev_b32 v4, 13, v2
    v_lshl_add_u32 v4, v3, 4, v4
    s_waitcnt lgkmcnt(0)
    s_mov_b32 s12, s8
    s_and_b32 s13, s9, 0xffff
    s_mov_b32 s14, 7340032
    s_mov_b32 s15, 0x20000
    buffer_load_dwordx4 v[112:115], v4, s[12:15], s21 offen
    s_add_u32 s21, s21, 2048
    buffer_load_dwordx4 v[116:119], v4, s[12:15], s21 offen
    s_add_u32 s21, s21, 2048
    buffer_load_dwordx4 v[120:123], v4, s[12:15], s21 offen
    s_add_u32 s21, s21, 2048
    buffer_load_dwordx4 v[124:127], v4, s[12:15], s21 offen
    s_add_u32 s21, s21, 26624
    buffer_load_dwordx4 v[128:131], v4, s[12:15], s21 offen
    s_add_u32 s21, s21, 2048
    buffer_load_dwordx4 v[132:135], v4, s[12:15], s21 offen
    s_add_u32 s21, s21, 2048
    buffer_load_dwordx4 v[136:139], v4, s[12:15], s21 offen
    s_add_u32 s21, s21, 2048
    buffer_load_dwordx4 v[140:143], v4, s[12:15], s21 offen
    s_waitcnt lgkmcnt(7)
    buffer_store_dwordx4 v[16:19], v7, s[16:19], s28 offen sc1
    s_waitcnt lgkmcnt(6)
    buffer_store_dwordx4 v[20:23], v7, s[16:19], s29 offen sc1
    s_waitcnt lgkmcnt(5)
    buffer_store_dwordx4 v[24:27], v7, s[16:19], s30 offen sc1
    s_waitcnt lgkmcnt(4)
    buffer_store_dwordx4 v[28:31], v7, s[16:19], s31 offen sc1
    s_waitcnt lgkmcnt(3)
    buffer_store_dwordx4 v[32:35], v7, s[16:19], s32 offen sc1
    s_waitcnt lgkmcnt(2)
    buffer_store_dwordx4 v[36:39], v7, s[16:19], s33 offen sc1
    s_waitcnt lgkmcnt(1)
    buffer_store_dwordx4 v[40:43], v7, s[16:19], s34 offen sc1
    s_waitcnt lgkmcnt(0)
    buffer_store_dwordx4 v[44:47], v7, s[16:19], s35 offen sc1
    s_load_dwordx2 s[92:93], s[0:1], 0
    s_lshl_b32 s91, s2, 14
    v_lshrrev_b32 v208, 6, v0
    v_lshlrev_b32 v208, 11, v208
    v_lshl_add_u32 v208, v1, 4, v208
    s_waitcnt lgkmcnt(0)
    s_and_b32 s93, s93, 0xffff
    s_mov_b32 s94, 4194304
    s_mov_b32 s95, 0x20000
    buffer_load_dwordx4 v[200:203], v208, s[92:95], s91 offen
    buffer_load_dwordx4 v[204:207], v208, s[92:95], s91 offen offset:1024
    s_barrier
    s_branch Lf_join
Lf_idle:
    s_waitcnt lgkmcnt(0)
    s_barrier
    s_cmp_lg_u32 s3, 4
    s_cbranch_scc1 Lf_ni
    s_load_dwordx2 s[64:65], s[0:1], 96
    v_mov_b32 v82, 0
    s_waitcnt lgkmcnt(0)
    s_and_b32 s65, s65, 0xffff
    s_mov_b32 s66, 8
    s_mov_b32 s67, 0x20000
    s_mov_b32 s58, 0x40000
    buffer_load_dwordx2 v[86:87], v82, s[64:67], 0 offen sc1
Li_np:
    s_waitcnt vmcnt(0)
    v_readfirstlane_b32 s72, v86
    v_readfirstlane_b32 s73, v87
    s_nop 3
    s_cmp_lg_u64 s[72:73], 0
    s_cbranch_scc1 Li_ng
    s_sub_u32 s58, s58, 1
    s_cbranch_scc1 Li_ng
    buffer_load_dwordx2 v[86:87], v82, s[64:67], 0 offen sc1
    s_branch Li_np
Li_ng:
Lf_ni:
    s_barrier
    s_barrier
    s_load_dwordx2 s[92:93], s[0:1], 0
    s_lshl_b32 s91, s2, 14
    v_lshrrev_b32 v208, 6, v0
    v_lshlrev_b32 v208, 11, v208
    v_lshl_add_u32 v208, v1, 4, v208
    s_waitcnt lgkmcnt(0)
    s_and_b32 s93, s93, 0xffff
    s_mov_b32 s94, 4194304
    s_mov_b32 s95, 0x20000
    buffer_load_dwordx4 v[200:203], v208, s[92:95], s91 offen
    buffer_load_dwordx4 v[204:207], v208, s[92:95], s91 offen offset:1024
    s_barrier
    s_branch Lf_join
.section .rodata,"a"
.p2align 6
.amdhsa_kernel mlp_kernel
  .amdhsa_next_free_vgpr 248
  .amdhsa_next_free_sgpr 100
  .amdhsa_accum_offset 248
  .amdhsa_group_segment_fixed_size 0
  .amdhsa_kernarg_size 112
  .amdhsa_user_sgpr_count 2
  .amdhsa_user_sgpr_kernarg_segment_ptr 1
  .amdhsa_system_sgpr_workgroup_id_x 1
.end_amdhsa_kernel
```
